```python
import torch

def _softmax(x, axis=-1):
    return torch.softmax(x, dim=axis)
def _gelu(x):
    return torch.nn.functional.gelu(x, approximate="tanh")
def _silu(x):
    return torch.nn.functional.silu(x)
def _sigmoid(x):
    return torch.sigmoid(x)
def _layernorm(x, axis=-1, eps=1e-5):
    m = x.mean(dim=axis, keepdim=True)
    v = x.var(dim=axis, keepdim=True, unbiased=False)
    return (x - m) / torch.sqrt(v + eps)
def _scatter_add(tgt, idx, src, axis=0):
    return tgt.clone().index_add_(axis, idx, src)
def _segment_sum(src, seg, n):
    out = torch.zeros((n,) + src.shape[1:], dtype=src.dtype)
    return out.index_add_(0, seg, src)
def _pad(x, pw):
    flat = tuple(v for pair in reversed(pw) for v in pair)
    return torch.nn.functional.pad(x, flat)

kernel_name = 'standalone__gqa_block_cached__near_ridge'

def setup_inputs():

    _w = (lambda a: (lambda t: t.to(torch.bfloat16) if t.is_floating_point() else t)(torch.as_tensor(a)))
    B, Sq, D = 16, 80, 448
    Hq, Hkv, Sk, Dh = 16, 8, 512, 256
    assert Hq % Hkv == 0, (Hq, Hkv)
    return {
        "x": _w((lambda *s: torch.randn(*s, dtype=torch.bfloat16) * 0.8)(B, Sq, D)),
        "k_cache": _w((lambda *s: torch.randn(*s, dtype=torch.bfloat16) * 0.8)(B, Hkv, Sk, Dh)),
        "v_cache": _w((lambda *s: torch.randn(*s, dtype=torch.bfloat16) * 0.05)(B, Hkv, Sk, Dh)),
        "wq": _w((lambda *s: torch.randn(*s, dtype=torch.bfloat16) * 0.8)(D, Hq * Dh) * (D ** -0.5)),
        "wo": _w((lambda *s: torch.randn(*s, dtype=torch.bfloat16) * 0.05)(Hq * Dh, D) * ((Hq * Dh) ** -0.5)),
    }

def reference(x, k_cache, v_cache, wq, wo):
    B, Sq, D = x.shape
    Hq, Dh = 16, 256
    Hkv = k_cache.shape[1]
    rep = Hq // Hkv
    q = (lambda x, *d: x.permute(*d))((x @ wq).reshape(B, Sq, Hq, Dh), 0, 2, 1, 3)
    k = (lambda x, n, axis: torch.repeat_interleave(x, n, dim=axis))(k_cache, rep, axis=1)
    v = (lambda x, n, axis: torch.repeat_interleave(x, n, dim=axis))(v_cache, rep, axis=1)
    scores = torch.einsum("bhqd,bhkd->bhqk", q, k) * (Dh ** -0.5)
    p = _softmax(scores, axis=-1)
    o = torch.einsum("bhqk,bhkd->bhqd", p, v)
    return (lambda x, *d: x.permute(*d))(o, 0, 2, 1, 3).reshape(B, Sq, Hq * Dh) @ wo
```

```asm
; @launch grid=(256,1,1) block=(256,1,1) lds=163840
.amdgcn_target "amdgcn-amd-amdhsa--gfx950"
.text
.globl standalone__gqa_block_cached__near_ridge_kernel
.p2align 8
.type standalone__gqa_block_cached__near_ridge_kernel,@function
standalone__gqa_block_cached__near_ridge_kernel:
    s_cmp_ge_u32 s2, 256
    s_cbranch_scc1 L_exit
L_pathA:
    s_load_dwordx8 s[64:71], s[0:1], 0
    s_load_dwordx8 s[72:79], s[0:1], 32
    s_memrealtime s[98:99]
    v_lshrrev_b32 v40, 6, v0
    v_and_b32 v0, 63, v0
    v_readfirstlane_b32 s32, v40
    s_getpc_b64 s[80:81]
    s_and_b32 s42, s2, 7
    s_lshr_b32 s38, s2, 3
    s_lshr_b32 s40, s38, 1
    s_and_b32 s38, s38, 1
    s_lshl_b32 s41, s42, 1
    s_add_u32 s41, s41, s38
    s_mul_i32 s4, s38, 4
    s_mul_i32 s3, s40, 0
    s_add_u32 s4, s4, s3
    s_mul_i32 s3, s4, 9363
    s_lshr_b32 s3, s3, 16
    s_mul_i32 s3, s3, 7
    s_sub_u32 s4, s4, s3
    s_lshl_b32 s3, s4, 19
    s_lshr_b32 s39, s32, 1
    s_add_u32 s4, s4, s39
    s_add_u32 s5, s4, 0
    s_sub_u32 s39, s5, 7
    s_cmp_ge_u32 s5, 7
    s_cselect_b32 s5, s39, s5
    s_lshl_b32 s5, s5, 7
    s_add_u32 s6, s4, 2
    s_sub_u32 s39, s6, 7
    s_cmp_ge_u32 s6, 7
    s_cselect_b32 s6, s39, s6
    s_lshl_b32 s6, s6, 7
    s_add_u32 s7, s4, 4
    s_sub_u32 s39, s7, 7
    s_cmp_ge_u32 s7, 7
    s_cselect_b32 s7, s39, s7
    s_lshl_b32 s7, s7, 7
    s_add_u32 s63, s4, 6
    s_sub_u32 s39, s63, 7
    s_cmp_ge_u32 s63, 7
    s_cselect_b32 s63, s39, s63
    s_lshl_b32 s63, s63, 7
    s_cmp_ge_u32 s32, 2
    s_cselect_b32 s63, 0x4000000, s63
    s_mul_i32 s100, s38, 0
    s_mul_i32 s101, s38, 0
    v_lshrrev_b32 v40, 3, v0
    v_lshrrev_b32 v41, 4, v0
    v_lshlrev_b32 v41, 1, v41
    v_and_b32 v42, 7, v0
    v_xor_b32 v42, v42, v41
    v_lshlrev_b32 v43, 4, v42
    v_lshrrev_b32 v44, 5, v0
    v_lshlrev_b32 v44, 3, v44
    v_and_b32 v45, 3, v40
    v_add_u32 v44, v44, v45
    v_lshl_add_u32 v8, v44, 13, v43
    v_add_u32 v9, 130048, v8
    v_add_u32 v10, 30720, v8
    v_add_u32 v11, 160768, v8
    v_mul_u32_u24 v44, 896, v40
    v_add_u32 v12, v44, v43
    v_lshlrev_b32 v46, 13, v0
    s_mul_i32 s43, s32, 20480
    s_add_u32 s33, s43, 81920
    s_lshl_b32 s38, s41, 9
    s_lshl_b32 s39, s32, 7
    s_add_u32 s35, s38, s39
    s_and_b32 s38, s32, 1
    s_lshr_b32 s39, s32, 1
    s_mul_i32 s96, s38, 5120
    s_mul_i32 s34, s39, 20480
    s_add_u32 s96, s96, s34
    s_mul_i32 s36, s38, 35840
    s_add_u32 s5, s5, s36
    s_add_u32 s6, s6, s36
    s_add_u32 s7, s7, s36
    s_add_u32 s63, s63, s36
    s_mul_i32 s38, s40, 71680
    s_waitcnt lgkmcnt(0)
    s_add_u32 s12, s70, s35
    s_addc_u32 s13, s71, 0
    s_sub_u32 s14, 3670016, s35
    s_mov_b32 s15, 0x00020000
    s_add_u32 s8, s64, s38
    s_addc_u32 s9, s65, 0
    s_mov_b32 s10, 71680
    s_mov_b32 s11, 0x00020000
    s_add_u32 m0, s33, 0
    s_nop 0
    buffer_load_dwordx4 v8, s[12:15], s3 offen offset:0 lds
    buffer_load_dwordx4 v9, s[12:15], s3 offen offset:1024 lds
    buffer_load_dwordx4 v10, s[12:15], s3 offen offset:2048 lds
    buffer_load_dwordx4 v11, s[12:15], s3 offen offset:3072 lds
    s_add_u32 s3, s3, 262144
    s_add_u32 m0, s96, 0
    s_add_u32 s34, s5, 0
    buffer_load_dwordx4 v12, s[8:11], s34 offen lds
    s_add_u32 m0, s96, 1024
    s_add_u32 s34, s5, 7168
    buffer_load_dwordx4 v12, s[8:11], s34 offen lds
    s_add_u32 m0, s96, 2048
    s_add_u32 s34, s5, 14336
    buffer_load_dwordx4 v12, s[8:11], s34 offen lds
    s_add_u32 m0, s96, 3072
    s_add_u32 s34, s5, 21504
    buffer_load_dwordx4 v12, s[8:11], s34 offen lds
    s_add_u32 m0, s96, 4096
    s_add_u32 s34, s5, 28672
    buffer_load_dwordx4 v12, s[8:11], s34 offen lds
    s_add_u32 m0, s33, 4096
    s_nop 0
    buffer_load_dwordx4 v8, s[12:15], s3 offen offset:0 lds
    buffer_load_dwordx4 v9, s[12:15], s3 offen offset:1024 lds
    buffer_load_dwordx4 v10, s[12:15], s3 offen offset:2048 lds
    buffer_load_dwordx4 v11, s[12:15], s3 offen offset:3072 lds
    s_add_u32 s3, s3, 262144
    s_cmp_eq_u32 s3, 3670016
    s_cselect_b32 s3, 0, s3
    v_cmp_gt_u32 vcc, 28, v0
    v_mov_b32 v47, 0x7f000000
    v_lshlrev_b32 v3, 7, v0
    v_cndmask_b32 v46, v47, v46, vcc
    v_cndmask_b32 v3, v47, v3, vcc
    s_mul_i32 s34, s40, 229376
    buffer_load_dword v253, v46, s[12:15], s34 offen
    s_mov_b32 s82, L_endA-L_pathA-64
    s_mov_b32 s83, 0x00020000
    v_cmp_gt_u32 vcc, 2, v0
    s_lshr_b32 s34, s2, 3
    s_lshl_b32 s34, s34, 2
    v_cndmask_b32 v47, v47, v3, vcc
    s_add_u32 s34, s34, s32
    s_lshl_b32 s34, s34, 8
    buffer_load_dword v253, v47, s[80:83], s34 offen
    s_add_u32 m0, s33, 8192
    s_nop 0
    buffer_load_dwordx4 v8, s[12:15], s3 offen offset:0 lds
    buffer_load_dwordx4 v9, s[12:15], s3 offen offset:1024 lds
    buffer_load_dwordx4 v10, s[12:15], s3 offen offset:2048 lds
    buffer_load_dwordx4 v11, s[12:15], s3 offen offset:3072 lds
    s_add_u32 s3, s3, 262144
    v_lshl_add_u32 v4, v40, 9, v43
    v_add_u32 v5, 3072, v4
    v_add_u32 v6, 6144, v4
    v_add_u32 v7, 9216, v4
    s_lshl_b32 s38, s40, 3
    s_add_u32 s38, s38, s42
    s_lshl_b32 s38, s38, 18
    s_lshl_b32 s39, s32, 16
    s_add_u32 s39, s39, s38
    s_add_u32 s16, s66, s39
    s_addc_u32 s17, s67, 0
    s_mov_b32 s18, 65536
    s_mov_b32 s19, 0x00020000
    s_lshl_b32 s39, s32, 7
    s_add_u32 s38, s38, s39
    s_add_u32 s20, s68, s38
    s_addc_u32 s21, s69, 0
    s_sub_u32 s22, 262144, s39
    s_mov_b32 s23, 0x00020000
    v_lshlrev_b32 v1, 4, v0
    v_add_u32 v2, 40960, v1
    s_mov_b32 s37, 0x3db8aa3b
    v_add_u32 v13, 6144, v12
    v_add_u32 v14, 12288, v12
    v_add_u32 v15, 18432, v12
    v_cmp_le_u32 vcc, 6, v42
    v_subrev_u32 v45, 2, v42
    s_nop 0
    v_cndmask_b32 v45, v42, v45, vcc
    v_lshl_add_u32 v16, v45, 4, v44
    v_add_u32 v17, 6144, v16
    v_add_u32 v18, 12288, v16
    v_add_u32 v19, 18432, v16
    s_mul_i32 s38, s41, 229376
    s_add_u32 s24, s72, s38
    s_addc_u32 s25, s73, 0
    s_mov_b32 s26, 229376
    s_mov_b32 s27, 0x00020000
    s_lshl_b32 s35, s32, 7
    s_mul_i32 s36, s32, 96
    s_add_u32 s36, s36, 512
    s_lshl_b32 s38, s40, 4
    s_add_u32 s38, s38, s41
    s_mul_i32 s38, s38, 73856
    s_mul_i32 s39, s32, 18432
    s_add_u32 s38, s38, s39
    s_add_u32 s28, s78, s38
    s_addc_u32 s29, s79, 0
    s_mov_b32 s30, 18432
    s_mov_b32 s31, 0x00020000
    s_mul_i32 s38, s40, 1181696
    s_add_u32 s38, s38, s39
    s_add_u32 s88, s78, s38
    s_addc_u32 s89, s79, 0
    s_sub_u32 s90, 1181696, s39
    s_mov_b32 s91, 0x00020000
    s_lshl_b32 s38, s40, 2
    s_add_u32 s38, s38, s32
    s_mul_i32 s97, s38, 3584
    s_lshl_b32 s38, s38, 12
    s_add_u32 s38, s38, 33554432
    s_add_u32 s84, s78, s38
    s_addc_u32 s85, s79, 0
    s_mov_b32 s86, 4096
    s_mov_b32 s87, 0x00020000
    s_mul_i32 s38, s40, 71680
    s_add_u32 s92, s74, s38
    s_addc_u32 s93, s75, 0
    s_mov_b32 s94, 71680
    s_mov_b32 s95, 0x00020000
    s_mov_b32 s80, s76
    s_mov_b32 s81, s77
    s_mov_b32 s82, 256
    s_mov_b32 s83, 0x00020000
    v_lshrrev_b32 v40, 2, v0
    v_lshlrev_b32 v40, 7, v40
    v_and_b32 v41, 3, v0
    v_lshl_add_u32 v40, v41, 3, v40
    v_add_u32 v40, s33, v40
    v_bfe_u32 v41, v0, 3, 2
    v_xor_b32 v42, 0, v41
    v_lshl_add_u32 v20, v42, 5, v40
    v_xor_b32 v42, 1, v41
    v_lshl_add_u32 v21, v42, 5, v40
    v_xor_b32 v42, 2, v41
    v_lshl_add_u32 v22, v42, 5, v40
    v_xor_b32 v42, 3, v41
    v_lshl_add_u32 v23, v42, 5, v40
    v_and_b32 v40, 15, v0
    v_lshrrev_b32 v41, 4, v0
    v_bfe_u32 v42, v0, 1, 2
    v_lshlrev_b32 v42, 1, v42
    v_xor_b32 v42, v42, v41
    v_lshlrev_b32 v43, 7, v40
    v_xor_b32 v44, 0, v42
    v_lshl_add_u32 v26, v44, 4, v43
    v_add_u32 v28, 40960, v26
    v_add_u32 v24, s33, v26
    v_xor_b32 v44, 4, v42
    v_lshl_add_u32 v27, v44, 4, v43
    v_add_u32 v29, 40960, v27
    v_add_u32 v25, s33, v27
    v_lshrrev_b32 v42, 1, v41
    v_lshl_add_u32 v42, v42, 4, v40
    v_lshlrev_b32 v42, 4, v42
    v_and_b32 v43, 1, v41
    v_lshl_add_u32 v42, v43, 3, v42
    v_add_u32 v30, s43, v42
    v_add_u32 v31, s43, v1
    v_mul_u32_u24 v42, 20480, v41
    v_lshl_add_u32 v42, v40, 4, v42
    v_add_u32 v43, s32, v41
    v_and_b32 v43, 3, v43
    v_lshl_add_u32 v32, v43, 2, v42
    v_lshlrev_b32 v42, 4, v40
    v_add_u32 v33, s43, v42
    s_or_b32 s98, s98, 1
    v_mov_b32 v254, s98
    v_mov_b32 v255, s99
    s_lshl_b32 s38, s2, 2
    s_add_u32 s38, s38, s32
    s_lshl_b32 s38, s38, 8
    v_lshlrev_b32 v42, 8, v0
    buffer_store_dwordx2 v[254:255], v42, s[80:83], s38 offen sc0 sc1
    s_waitcnt vmcnt(11)
    s_barrier
    ds_read_b64_tr_b16 a[160:161], v20 offset:0
    ds_read_b64_tr_b16 a[162:163], v20 offset:2048
    ds_read_b64_tr_b16 a[164:165], v21 offset:0
    ds_read_b64_tr_b16 a[166:167], v21 offset:2048
    ds_read_b64_tr_b16 a[168:169], v22 offset:0
    ds_read_b64_tr_b16 a[170:171], v22 offset:2048
    ds_read_b64_tr_b16 a[172:173], v23 offset:0
    ds_read_b64_tr_b16 a[174:175], v23 offset:2048
    ds_read_b128 a[192:195], v26 offset:0
    ds_read_b128 a[196:199], v26 offset:2048
    ds_read_b128 a[200:203], v26 offset:4096
    ds_read_b128 a[204:207], v26 offset:6144
    ds_read_b128 a[208:211], v26 offset:8192
    s_waitcnt lgkmcnt(0)
    v_mfma_f32_16x16x32_bf16 v[48:51], a[160:163], a[192:195], 0
    s_add_u32 m0, s33, 0
    v_mfma_f32_16x16x32_bf16 v[52:55], a[160:163], a[196:199], 0
    s_nop 0
    buffer_load_dwordx4 v8, s[12:15], s3 offen offset:0 lds
    v_mfma_f32_16x16x32_bf16 v[56:59], a[160:163], a[200:203], 0
    buffer_load_dwordx4 v9, s[12:15], s3 offen offset:1024 lds
    buffer_load_dwordx4 v10, s[12:15], s3 offen offset:2048 lds
    v_mfma_f32_16x16x32_bf16 v[60:63], a[160:163], a[204:207], 0
    buffer_load_dwordx4 v11, s[12:15], s3 offen offset:3072 lds
    s_add_u32 s3, s3, 262144
    v_mfma_f32_16x16x32_bf16 v[64:67], a[160:163], a[208:211], 0
    s_cmp_eq_u32 s3, 3670016
    s_cselect_b32 s3, 0, s3
    s_add_u32 m0, s96, 40960
    v_mfma_f32_16x16x32_bf16 v[68:71], a[164:167], a[192:195], 0
    s_add_u32 s34, s6, 0
    buffer_load_dwordx4 v12, s[8:11], s34 offen lds
    v_mfma_f32_16x16x32_bf16 v[72:75], a[164:167], a[196:199], 0
    s_add_u32 m0, s96, 41984
    s_add_u32 s34, s6, 7168
    v_mfma_f32_16x16x32_bf16 v[76:79], a[164:167], a[200:203], 0
    buffer_load_dwordx4 v12, s[8:11], s34 offen lds
    s_add_u32 m0, s96, 43008
    v_mfma_f32_16x16x32_bf16 v[80:83], a[164:167], a[204:207], 0
    s_add_u32 s34, s6, 14336
    buffer_load_dwordx4 v12, s[8:11], s34 offen lds
    v_mfma_f32_16x16x32_bf16 v[84:87], a[164:167], a[208:211], 0
    s_add_u32 m0, s96, 44032
    v_mfma_f32_16x16x32_bf16 v[88:91], a[168:171], a[192:195], 0
    s_add_u32 s34, s6, 21504
    buffer_load_dwordx4 v12, s[8:11], s34 offen lds
    v_mfma_f32_16x16x32_bf16 v[92:95], a[168:171], a[196:199], 0
    s_add_u32 m0, s96, 45056
    s_add_u32 s34, s6, 28672
    v_mfma_f32_16x16x32_bf16 v[96:99], a[168:171], a[200:203], 0
    buffer_load_dwordx4 v12, s[8:11], s34 offen lds
    ds_read_b128 a[212:215], v27 offset:0
    v_mfma_f32_16x16x32_bf16 v[100:103], a[168:171], a[204:207], 0
    ds_read_b128 a[216:219], v27 offset:2048
    ds_read_b128 a[220:223], v27 offset:4096
    v_mfma_f32_16x16x32_bf16 v[104:107], a[168:171], a[208:211], 0
    ds_read_b128 a[224:227], v27 offset:6144
    ds_read_b128 a[228:231], v27 offset:8192
    v_mfma_f32_16x16x32_bf16 v[108:111], a[172:175], a[192:195], 0
    s_waitcnt vmcnt(16)
    ds_read_b64_tr_b16 a[176:177], v20 offset:4096
    v_mfma_f32_16x16x32_bf16 v[112:115], a[172:175], a[196:199], 0
    ds_read_b64_tr_b16 a[178:179], v20 offset:6144
    ds_read_b64_tr_b16 a[180:181], v21 offset:4096
    v_mfma_f32_16x16x32_bf16 v[116:119], a[172:175], a[200:203], 0
    ds_read_b64_tr_b16 a[182:183], v21 offset:6144
    ds_read_b64_tr_b16 a[184:185], v22 offset:4096
    v_mfma_f32_16x16x32_bf16 v[120:123], a[172:175], a[204:207], 0
    ds_read_b64_tr_b16 a[186:187], v22 offset:6144
    ds_read_b64_tr_b16 a[188:189], v23 offset:4096
    v_mfma_f32_16x16x32_bf16 v[124:127], a[172:175], a[208:211], 0
    ds_read_b64_tr_b16 a[190:191], v23 offset:6144
    s_waitcnt lgkmcnt(0)
    v_mfma_f32_16x16x32_bf16 v[48:51], a[176:179], a[212:215], v[48:51]
    s_add_u32 m0, s33, 4096
    v_mfma_f32_16x16x32_bf16 v[52:55], a[176:179], a[216:219], v[52:55]
    s_nop 0
    buffer_load_dwordx4 v8, s[12:15], s3 offen offset:0 lds
    v_mfma_f32_16x16x32_bf16 v[56:59], a[176:179], a[220:223], v[56:59]
    buffer_load_dwordx4 v9, s[12:15], s3 offen offset:1024 lds
    buffer_load_dwordx4 v10, s[12:15], s3 offen offset:2048 lds
    v_mfma_f32_16x16x32_bf16 v[60:63], a[176:179], a[224:227], v[60:63]
    buffer_load_dwordx4 v11, s[12:15], s3 offen offset:3072 lds
    s_add_u32 s3, s3, 262144
    v_mfma_f32_16x16x32_bf16 v[64:67], a[176:179], a[228:231], v[64:67]
    s_add_u32 m0, s33, 12288
    s_nop 0
    v_mfma_f32_16x16x32_bf16 v[68:71], a[180:183], a[212:215], v[68:71]
    buffer_load_dwordx4 v8, s[12:15], s3 offen offset:0 lds
    buffer_load_dwordx4 v9, s[12:15], s3 offen offset:1024 lds
    v_mfma_f32_16x16x32_bf16 v[72:75], a[180:183], a[216:219], v[72:75]
    buffer_load_dwordx4 v10, s[12:15], s3 offen offset:2048 lds
    buffer_load_dwordx4 v11, s[12:15], s3 offen offset:3072 lds
    v_mfma_f32_16x16x32_bf16 v[76:79], a[180:183], a[220:223], v[76:79]
    s_add_u32 s3, s3, 262144
    s_cmp_eq_u32 s3, 3670016
    s_cselect_b32 s3, 0, s3
    v_mfma_f32_16x16x32_bf16 v[80:83], a[180:183], a[224:227], v[80:83]
    ds_read_b128 a[192:195], v26 offset:20480
    ds_read_b128 a[196:199], v26 offset:22528
    v_mfma_f32_16x16x32_bf16 v[84:87], a[180:183], a[228:231], v[84:87]
    ds_read_b128 a[200:203], v26 offset:24576
    ds_read_b128 a[204:207], v26 offset:26624
    v_mfma_f32_16x16x32_bf16 v[88:91], a[184:187], a[212:215], v[88:91]
    ds_read_b128 a[208:211], v26 offset:28672
    s_waitcnt vmcnt(18)
    v_mfma_f32_16x16x32_bf16 v[92:95], a[184:187], a[216:219], v[92:95]
    ds_read_b64_tr_b16 a[160:161], v20 offset:8192
    ds_read_b64_tr_b16 a[162:163], v20 offset:10240
    v_mfma_f32_16x16x32_bf16 v[96:99], a[184:187], a[220:223], v[96:99]
    ds_read_b64_tr_b16 a[164:165], v21 offset:8192
    ds_read_b64_tr_b16 a[166:167], v21 offset:10240
    v_mfma_f32_16x16x32_bf16 v[100:103], a[184:187], a[224:227], v[100:103]
    ds_read_b64_tr_b16 a[168:169], v22 offset:8192
    ds_read_b64_tr_b16 a[170:171], v22 offset:10240
    v_mfma_f32_16x16x32_bf16 v[104:107], a[184:187], a[228:231], v[104:107]
    ds_read_b64_tr_b16 a[172:173], v23 offset:8192
    ds_read_b64_tr_b16 a[174:175], v23 offset:10240
    v_mfma_f32_16x16x32_bf16 v[108:111], a[188:191], a[212:215], v[108:111]
    v_mfma_f32_16x16x32_bf16 v[112:115], a[188:191], a[216:219], v[112:115]
    v_mfma_f32_16x16x32_bf16 v[116:119], a[188:191], a[220:223], v[116:119]
    v_mfma_f32_16x16x32_bf16 v[120:123], a[188:191], a[224:227], v[120:123]
    v_mfma_f32_16x16x32_bf16 v[124:127], a[188:191], a[228:231], v[124:127]
    s_waitcnt lgkmcnt(0)
    v_mfma_f32_16x16x32_bf16 v[48:51], a[160:163], a[192:195], v[48:51]
    s_add_u32 m0, s33, 8192
    v_mfma_f32_16x16x32_bf16 v[52:55], a[160:163], a[196:199], v[52:55]
    s_nop 0
    buffer_load_dwordx4 v8, s[12:15], s3 offen offset:0 lds
    v_mfma_f32_16x16x32_bf16 v[56:59], a[160:163], a[200:203], v[56:59]
    buffer_load_dwordx4 v9, s[12:15], s3 offen offset:1024 lds
    buffer_load_dwordx4 v10, s[12:15], s3 offen offset:2048 lds
    v_mfma_f32_16x16x32_bf16 v[60:63], a[160:163], a[204:207], v[60:63]
    buffer_load_dwordx4 v11, s[12:15], s3 offen offset:3072 lds
    s_add_u32 s3, s3, 262144
    v_mfma_f32_16x16x32_bf16 v[64:67], a[160:163], a[208:211], v[64:67]
    s_add_u32 m0, s96, 10240
    s_add_u32 s34, s7, 0
    v_mfma_f32_16x16x32_bf16 v[68:71], a[164:167], a[192:195], v[68:71]
    buffer_load_dwordx4 v12, s[8:11], s34 offen lds
    s_add_u32 m0, s96, 11264
    v_mfma_f32_16x16x32_bf16 v[72:75], a[164:167], a[196:199], v[72:75]
    s_add_u32 s34, s7, 7168
    v_mfma_f32_16x16x32_bf16 v[76:79], a[164:167], a[200:203], v[76:79]
    buffer_load_dwordx4 v12, s[8:11], s34 offen lds
    s_add_u32 m0, s96, 12288
    v_mfma_f32_16x16x32_bf16 v[80:83], a[164:167], a[204:207], v[80:83]
    s_add_u32 s34, s7, 14336
    buffer_load_dwordx4 v12, s[8:11], s34 offen lds
    v_mfma_f32_16x16x32_bf16 v[84:87], a[164:167], a[208:211], v[84:87]
    s_add_u32 m0, s96, 13312
    s_add_u32 s34, s7, 21504
    v_mfma_f32_16x16x32_bf16 v[88:91], a[168:171], a[192:195], v[88:91]
    buffer_load_dwordx4 v12, s[8:11], s34 offen lds
    s_add_u32 m0, s96, 14336
    v_mfma_f32_16x16x32_bf16 v[92:95], a[168:171], a[196:199], v[92:95]
    s_add_u32 s34, s7, 28672
    buffer_load_dwordx4 v12, s[8:11], s34 offen lds
    v_mfma_f32_16x16x32_bf16 v[96:99], a[168:171], a[200:203], v[96:99]
    ds_read_b128 a[212:215], v27 offset:20480
    ds_read_b128 a[216:219], v27 offset:22528
    v_mfma_f32_16x16x32_bf16 v[100:103], a[168:171], a[204:207], v[100:103]
    ds_read_b128 a[220:223], v27 offset:24576
    v_mfma_f32_16x16x32_bf16 v[104:107], a[168:171], a[208:211], v[104:107]
    ds_read_b128 a[224:227], v27 offset:26624
    ds_read_b128 a[228:231], v27 offset:28672
    v_mfma_f32_16x16x32_bf16 v[108:111], a[172:175], a[192:195], v[108:111]
    s_waitcnt vmcnt(22)
    ds_read_b64_tr_b16 a[176:177], v20 offset:0
    v_mfma_f32_16x16x32_bf16 v[112:115], a[172:175], a[196:199], v[112:115]
    ds_read_b64_tr_b16 a[178:179], v20 offset:2048
    ds_read_b64_tr_b16 a[180:181], v21 offset:0
    v_mfma_f32_16x16x32_bf16 v[116:119], a[172:175], a[200:203], v[116:119]
    ds_read_b64_tr_b16 a[182:183], v21 offset:2048
    ds_read_b64_tr_b16 a[184:185], v22 offset:0
    v_mfma_f32_16x16x32_bf16 v[120:123], a[172:175], a[204:207], v[120:123]
    ds_read_b64_tr_b16 a[186:187], v22 offset:2048
    ds_read_b64_tr_b16 a[188:189], v23 offset:0
    v_mfma_f32_16x16x32_bf16 v[124:127], a[172:175], a[208:211], v[124:127]
    ds_read_b64_tr_b16 a[190:191], v23 offset:2048
    s_waitcnt lgkmcnt(0)
    v_mfma_f32_16x16x32_bf16 v[48:51], a[176:179], a[212:215], v[48:51]
    s_waitcnt vmcnt(17)
    s_barrier
    v_mfma_f32_16x16x32_bf16 v[52:55], a[176:179], a[216:219], v[52:55]
    s_add_u32 m0, s33, 0
    v_mfma_f32_16x16x32_bf16 v[56:59], a[176:179], a[220:223], v[56:59]
    s_nop 0
    buffer_load_dwordx4 v8, s[12:15], s3 offen offset:0 lds
    v_mfma_f32_16x16x32_bf16 v[60:63], a[176:179], a[224:227], v[60:63]
    buffer_load_dwordx4 v9, s[12:15], s3 offen offset:1024 lds
    buffer_load_dwordx4 v10, s[12:15], s3 offen offset:2048 lds
    v_mfma_f32_16x16x32_bf16 v[64:67], a[176:179], a[228:231], v[64:67]
    buffer_load_dwordx4 v11, s[12:15], s3 offen offset:3072 lds
    s_add_u32 s3, s3, 262144
    v_mfma_f32_16x16x32_bf16 v[68:71], a[180:183], a[212:215], v[68:71]
    s_cmp_eq_u32 s3, 3670016
    s_cselect_b32 s3, 0, s3
    s_add_u32 m0, s33, 16384
    v_mfma_f32_16x16x32_bf16 v[72:75], a[180:183], a[216:219], v[72:75]
    s_nop 0
    buffer_load_dwordx4 v8, s[12:15], s3 offen offset:0 lds
    v_mfma_f32_16x16x32_bf16 v[76:79], a[180:183], a[220:223], v[76:79]
    buffer_load_dwordx4 v9, s[12:15], s3 offen offset:1024 lds
    buffer_load_dwordx4 v10, s[12:15], s3 offen offset:2048 lds
    v_mfma_f32_16x16x32_bf16 v[80:83], a[180:183], a[224:227], v[80:83]
    buffer_load_dwordx4 v11, s[12:15], s3 offen offset:3072 lds
    s_add_u32 s3, s3, 262144
    v_mfma_f32_16x16x32_bf16 v[84:87], a[180:183], a[228:231], v[84:87]
    ds_read_b128 a[192:195], v28 offset:0
    ds_read_b128 a[196:199], v28 offset:2048
    v_mfma_f32_16x16x32_bf16 v[88:91], a[184:187], a[212:215], v[88:91]
    ds_read_b128 a[200:203], v28 offset:4096
    ds_read_b128 a[204:207], v28 offset:6144
    v_mfma_f32_16x16x32_bf16 v[92:95], a[184:187], a[216:219], v[92:95]
    ds_read_b128 a[208:211], v28 offset:8192
    s_waitcnt vmcnt(21)
    v_mfma_f32_16x16x32_bf16 v[96:99], a[184:187], a[220:223], v[96:99]
    ds_read_b64_tr_b16 a[160:161], v20 offset:4096
    ds_read_b64_tr_b16 a[162:163], v20 offset:6144
    v_mfma_f32_16x16x32_bf16 v[100:103], a[184:187], a[224:227], v[100:103]
    ds_read_b64_tr_b16 a[164:165], v21 offset:4096
    ds_read_b64_tr_b16 a[166:167], v21 offset:6144
    v_mfma_f32_16x16x32_bf16 v[104:107], a[184:187], a[228:231], v[104:107]
    ds_read_b64_tr_b16 a[168:169], v22 offset:4096
    ds_read_b64_tr_b16 a[170:171], v22 offset:6144
    v_mfma_f32_16x16x32_bf16 v[108:111], a[188:191], a[212:215], v[108:111]
    ds_read_b64_tr_b16 a[172:173], v23 offset:4096
    ds_read_b64_tr_b16 a[174:175], v23 offset:6144
    v_mfma_f32_16x16x32_bf16 v[112:115], a[188:191], a[216:219], v[112:115]
    v_mfma_f32_16x16x32_bf16 v[116:119], a[188:191], a[220:223], v[116:119]
    v_mfma_f32_16x16x32_bf16 v[120:123], a[188:191], a[224:227], v[120:123]
    v_mfma_f32_16x16x32_bf16 v[124:127], a[188:191], a[228:231], v[124:127]
    s_waitcnt lgkmcnt(0)
    v_mfma_f32_16x16x32_bf16 v[48:51], a[160:163], a[192:195], v[48:51]
    s_add_u32 m0, s33, 4096
    v_mfma_f32_16x16x32_bf16 v[52:55], a[160:163], a[196:199], v[52:55]
    s_nop 0
    buffer_load_dwordx4 v8, s[12:15], s3 offen offset:0 lds
    v_mfma_f32_16x16x32_bf16 v[56:59], a[160:163], a[200:203], v[56:59]
    buffer_load_dwordx4 v9, s[12:15], s3 offen offset:1024 lds
    buffer_load_dwordx4 v10, s[12:15], s3 offen offset:2048 lds
    v_mfma_f32_16x16x32_bf16 v[60:63], a[160:163], a[204:207], v[60:63]
    buffer_load_dwordx4 v11, s[12:15], s3 offen offset:3072 lds
    s_add_u32 s3, s3, 262144
    v_mfma_f32_16x16x32_bf16 v[64:67], a[160:163], a[208:211], v[64:67]
    s_cmp_eq_u32 s3, 3670016
    s_cselect_b32 s3, 0, s3
    s_add_u32 m0, s96, 51200
    v_mfma_f32_16x16x32_bf16 v[68:71], a[164:167], a[192:195], v[68:71]
    s_add_u32 s34, s63, 0
    buffer_load_dwordx4 v12, s[8:11], s34 offen lds
    v_mfma_f32_16x16x32_bf16 v[72:75], a[164:167], a[196:199], v[72:75]
    s_add_u32 m0, s96, 52224
    s_add_u32 s34, s63, 7168
    v_mfma_f32_16x16x32_bf16 v[76:79], a[164:167], a[200:203], v[76:79]
    buffer_load_dwordx4 v12, s[8:11], s34 offen lds
    s_add_u32 m0, s96, 53248
    v_mfma_f32_16x16x32_bf16 v[80:83], a[164:167], a[204:207], v[80:83]
    s_add_u32 s34, s63, 14336
    buffer_load_dwordx4 v12, s[8:11], s34 offen lds
    v_mfma_f32_16x16x32_bf16 v[84:87], a[164:167], a[208:211], v[84:87]
    s_add_u32 m0, s96, 54272
    v_mfma_f32_16x16x32_bf16 v[88:91], a[168:171], a[192:195], v[88:91]
    s_add_u32 s34, s63, 21504
    buffer_load_dwordx4 v12, s[8:11], s34 offen lds
    v_mfma_f32_16x16x32_bf16 v[92:95], a[168:171], a[196:199], v[92:95]
    s_add_u32 m0, s96, 55296
    s_add_u32 s34, s63, 28672
    v_mfma_f32_16x16x32_bf16 v[96:99], a[168:171], a[200:203], v[96:99]
    buffer_load_dwordx4 v12, s[8:11], s34 offen lds
    ds_read_b128 a[212:215], v29 offset:0
    v_mfma_f32_16x16x32_bf16 v[100:103], a[168:171], a[204:207], v[100:103]
    ds_read_b128 a[216:219], v29 offset:2048
    ds_read_b128 a[220:223], v29 offset:4096
    v_mfma_f32_16x16x32_bf16 v[104:107], a[168:171], a[208:211], v[104:107]
    ds_read_b128 a[224:227], v29 offset:6144
    ds_read_b128 a[228:231], v29 offset:8192
    v_mfma_f32_16x16x32_bf16 v[108:111], a[172:175], a[192:195], v[108:111]
    s_waitcnt vmcnt(26)
    ds_read_b64_tr_b16 a[176:177], v20 offset:12288
    v_mfma_f32_16x16x32_bf16 v[112:115], a[172:175], a[196:199], v[112:115]
    ds_read_b64_tr_b16 a[178:179], v20 offset:14336
    ds_read_b64_tr_b16 a[180:181], v21 offset:12288
    v_mfma_f32_16x16x32_bf16 v[116:119], a[172:175], a[200:203], v[116:119]
    ds_read_b64_tr_b16 a[182:183], v21 offset:14336
    ds_read_b64_tr_b16 a[184:185], v22 offset:12288
    v_mfma_f32_16x16x32_bf16 v[120:123], a[172:175], a[204:207], v[120:123]
    ds_read_b64_tr_b16 a[186:187], v22 offset:14336
    ds_read_b64_tr_b16 a[188:189], v23 offset:12288
    v_mfma_f32_16x16x32_bf16 v[124:127], a[172:175], a[208:211], v[124:127]
    ds_read_b64_tr_b16 a[190:191], v23 offset:14336
    s_waitcnt lgkmcnt(0)
    v_mfma_f32_16x16x32_bf16 v[48:51], a[176:179], a[212:215], v[48:51]
    s_add_u32 m0, s33, 12288
    v_mfma_f32_16x16x32_bf16 v[52:55], a[176:179], a[216:219], v[52:55]
    s_nop 0
    buffer_load_dwordx4 v8, s[12:15], s3 offen offset:0 lds
    v_mfma_f32_16x16x32_bf16 v[56:59], a[176:179], a[220:223], v[56:59]
    buffer_load_dwordx4 v9, s[12:15], s3 offen offset:1024 lds
    buffer_load_dwordx4 v10, s[12:15], s3 offen offset:2048 lds
    v_mfma_f32_16x16x32_bf16 v[60:63], a[176:179], a[224:227], v[60:63]
    buffer_load_dwordx4 v11, s[12:15], s3 offen offset:3072 lds
    s_add_u32 s3, s3, 262144
    v_mfma_f32_16x16x32_bf16 v[64:67], a[176:179], a[228:231], v[64:67]
    ds_read_b128 a[192:195], v28 offset:20480
    ds_read_b128 a[196:199], v28 offset:22528
    v_mfma_f32_16x16x32_bf16 v[68:71], a[180:183], a[212:215], v[68:71]
    ds_read_b128 a[200:203], v28 offset:24576
    ds_read_b128 a[204:207], v28 offset:26624
    v_mfma_f32_16x16x32_bf16 v[72:75], a[180:183], a[216:219], v[72:75]
    ds_read_b128 a[208:211], v28 offset:28672
    s_waitcnt vmcnt(26)
    v_mfma_f32_16x16x32_bf16 v[76:79], a[180:183], a[220:223], v[76:79]
    ds_read_b64_tr_b16 a[160:161], v20 offset:8192
    ds_read_b64_tr_b16 a[162:163], v20 offset:10240
    v_mfma_f32_16x16x32_bf16 v[80:83], a[180:183], a[224:227], v[80:83]
    ds_read_b64_tr_b16 a[164:165], v21 offset:8192
    ds_read_b64_tr_b16 a[166:167], v21 offset:10240
    v_mfma_f32_16x16x32_bf16 v[84:87], a[180:183], a[228:231], v[84:87]
    ds_read_b64_tr_b16 a[168:169], v22 offset:8192
    ds_read_b64_tr_b16 a[170:171], v22 offset:10240
    v_mfma_f32_16x16x32_bf16 v[88:91], a[184:187], a[212:215], v[88:91]
    ds_read_b64_tr_b16 a[172:173], v23 offset:8192
    ds_read_b64_tr_b16 a[174:175], v23 offset:10240
    v_mfma_f32_16x16x32_bf16 v[92:95], a[184:187], a[216:219], v[92:95]
    v_mfma_f32_16x16x32_bf16 v[96:99], a[184:187], a[220:223], v[96:99]
    v_mfma_f32_16x16x32_bf16 v[100:103], a[184:187], a[224:227], v[100:103]
    v_mfma_f32_16x16x32_bf16 v[104:107], a[184:187], a[228:231], v[104:107]
    v_mfma_f32_16x16x32_bf16 v[108:111], a[188:191], a[212:215], v[108:111]
    v_mfma_f32_16x16x32_bf16 v[112:115], a[188:191], a[216:219], v[112:115]
    v_mfma_f32_16x16x32_bf16 v[116:119], a[188:191], a[220:223], v[116:119]
    v_mfma_f32_16x16x32_bf16 v[120:123], a[188:191], a[224:227], v[120:123]
    v_mfma_f32_16x16x32_bf16 v[124:127], a[188:191], a[228:231], v[124:127]
    s_waitcnt lgkmcnt(0)
    v_mfma_f32_16x16x32_bf16 v[48:51], a[160:163], a[192:195], v[48:51]
    s_add_u32 m0, s33, 8192
    v_mfma_f32_16x16x32_bf16 v[52:55], a[160:163], a[196:199], v[52:55]
    s_nop 0
    buffer_load_dwordx4 v8, s[12:15], s3 offen offset:0 lds
    v_mfma_f32_16x16x32_bf16 v[56:59], a[160:163], a[200:203], v[56:59]
    buffer_load_dwordx4 v9, s[12:15], s3 offen offset:1024 lds
    buffer_load_dwordx4 v10, s[12:15], s3 offen offset:2048 lds
    v_mfma_f32_16x16x32_bf16 v[60:63], a[160:163], a[204:207], v[60:63]
    buffer_load_dwordx4 v11, s[12:15], s3 offen offset:3072 lds
    s_add_u32 s3, s3, 262144
    v_mfma_f32_16x16x32_bf16 v[64:67], a[160:163], a[208:211], v[64:67]
    s_cmp_eq_u32 s3, 3670016
    s_cselect_b32 s3, 0, s3
    ds_read_b128 a[212:215], v29 offset:20480
    v_mfma_f32_16x16x32_bf16 v[68:71], a[164:167], a[192:195], v[68:71]
    ds_read_b128 a[216:219], v29 offset:22528
    ds_read_b128 a[220:223], v29 offset:24576
    v_mfma_f32_16x16x32_bf16 v[72:75], a[164:167], a[196:199], v[72:75]
    ds_read_b128 a[224:227], v29 offset:26624
    ds_read_b128 a[228:231], v29 offset:28672
    v_mfma_f32_16x16x32_bf16 v[76:79], a[164:167], a[200:203], v[76:79]
    s_waitcnt vmcnt(21)
    ds_read_b64_tr_b16 a[176:177], v20 offset:0
    v_mfma_f32_16x16x32_bf16 v[80:83], a[164:167], a[204:207], v[80:83]
    ds_read_b64_tr_b16 a[178:179], v20 offset:2048
    ds_read_b64_tr_b16 a[180:181], v21 offset:0
    v_mfma_f32_16x16x32_bf16 v[84:87], a[164:167], a[208:211], v[84:87]
    ds_read_b64_tr_b16 a[182:183], v21 offset:2048
    ds_read_b64_tr_b16 a[184:185], v22 offset:0
    v_mfma_f32_16x16x32_bf16 v[88:91], a[168:171], a[192:195], v[88:91]
    ds_read_b64_tr_b16 a[186:187], v22 offset:2048
    ds_read_b64_tr_b16 a[188:189], v23 offset:0
    v_mfma_f32_16x16x32_bf16 v[92:95], a[168:171], a[196:199], v[92:95]
    ds_read_b64_tr_b16 a[190:191], v23 offset:2048
    v_mfma_f32_16x16x32_bf16 v[96:99], a[168:171], a[200:203], v[96:99]
    v_mfma_f32_16x16x32_bf16 v[100:103], a[168:171], a[204:207], v[100:103]
    v_mfma_f32_16x16x32_bf16 v[104:107], a[168:171], a[208:211], v[104:107]
    v_mfma_f32_16x16x32_bf16 v[108:111], a[172:175], a[192:195], v[108:111]
    v_mfma_f32_16x16x32_bf16 v[112:115], a[172:175], a[196:199], v[112:115]
    v_mfma_f32_16x16x32_bf16 v[116:119], a[172:175], a[200:203], v[116:119]
    v_mfma_f32_16x16x32_bf16 v[120:123], a[172:175], a[204:207], v[120:123]
    v_mfma_f32_16x16x32_bf16 v[124:127], a[172:175], a[208:211], v[124:127]
    s_waitcnt lgkmcnt(0)
    v_mfma_f32_16x16x32_bf16 v[48:51], a[176:179], a[212:215], v[48:51]
    s_waitcnt vmcnt(8)
    s_barrier
    v_mfma_f32_16x16x32_bf16 v[52:55], a[176:179], a[216:219], v[52:55]
    s_add_u32 m0, s33, 0
    v_mfma_f32_16x16x32_bf16 v[56:59], a[176:179], a[220:223], v[56:59]
    s_nop 0
    buffer_load_dwordx4 v8, s[12:15], s3 offen offset:0 lds
    v_mfma_f32_16x16x32_bf16 v[60:63], a[176:179], a[224:227], v[60:63]
    buffer_load_dwordx4 v9, s[12:15], s3 offen offset:1024 lds
    buffer_load_dwordx4 v10, s[12:15], s3 offen offset:2048 lds
    v_mfma_f32_16x16x32_bf16 v[64:67], a[176:179], a[228:231], v[64:67]
    buffer_load_dwordx4 v11, s[12:15], s3 offen offset:3072 lds
    s_add_u32 s3, s3, 262144
    v_mfma_f32_16x16x32_bf16 v[68:71], a[180:183], a[212:215], v[68:71]
    ds_read_b128 a[192:195], v26 offset:10240
    ds_read_b128 a[196:199], v26 offset:12288
    v_mfma_f32_16x16x32_bf16 v[72:75], a[180:183], a[216:219], v[72:75]
    ds_read_b128 a[200:203], v26 offset:14336
    ds_read_b128 a[204:207], v26 offset:16384
    v_mfma_f32_16x16x32_bf16 v[76:79], a[180:183], a[220:223], v[76:79]
    ds_read_b128 a[208:211], v26 offset:18432
    v_mfma_f32_16x16x32_bf16 v[80:83], a[180:183], a[224:227], v[80:83]
    ds_read_b64_tr_b16 a[160:161], v20 offset:16384
    ds_read_b64_tr_b16 a[162:163], v20 offset:18432
    v_mfma_f32_16x16x32_bf16 v[84:87], a[180:183], a[228:231], v[84:87]
    ds_read_b64_tr_b16 a[164:165], v21 offset:16384
    ds_read_b64_tr_b16 a[166:167], v21 offset:18432
    v_mfma_f32_16x16x32_bf16 v[88:91], a[184:187], a[212:215], v[88:91]
    ds_read_b64_tr_b16 a[168:169], v22 offset:16384
    ds_read_b64_tr_b16 a[170:171], v22 offset:18432
    v_mfma_f32_16x16x32_bf16 v[92:95], a[184:187], a[216:219], v[92:95]
    ds_read_b64_tr_b16 a[172:173], v23 offset:16384
    ds_read_b64_tr_b16 a[174:175], v23 offset:18432
    v_mfma_f32_16x16x32_bf16 v[96:99], a[184:187], a[220:223], v[96:99]
    v_mfma_f32_16x16x32_bf16 v[100:103], a[184:187], a[224:227], v[100:103]
    v_mfma_f32_16x16x32_bf16 v[104:107], a[184:187], a[228:231], v[104:107]
    v_mfma_f32_16x16x32_bf16 v[108:111], a[188:191], a[212:215], v[108:111]
    v_mfma_f32_16x16x32_bf16 v[112:115], a[188:191], a[216:219], v[112:115]
    v_mfma_f32_16x16x32_bf16 v[116:119], a[188:191], a[220:223], v[116:119]
    v_mfma_f32_16x16x32_bf16 v[120:123], a[188:191], a[224:227], v[120:123]
    v_mfma_f32_16x16x32_bf16 v[124:127], a[188:191], a[228:231], v[124:127]
    s_waitcnt lgkmcnt(0)
    v_mfma_f32_16x16x32_bf16 v[48:51], a[160:163], a[192:195], v[48:51]
    s_add_u32 m0, s33, 16384
    v_mfma_f32_16x16x32_bf16 v[52:55], a[160:163], a[196:199], v[52:55]
    s_nop 0
    buffer_load_dwordx4 v8, s[12:15], s3 offen offset:0 lds
    v_mfma_f32_16x16x32_bf16 v[56:59], a[160:163], a[200:203], v[56:59]
    buffer_load_dwordx4 v9, s[12:15], s3 offen offset:1024 lds
    buffer_load_dwordx4 v10, s[12:15], s3 offen offset:2048 lds
    v_mfma_f32_16x16x32_bf16 v[60:63], a[160:163], a[204:207], v[60:63]
    buffer_load_dwordx4 v11, s[12:15], s3 offen offset:3072 lds
    s_add_u32 s3, s3, 262144
    v_mfma_f32_16x16x32_bf16 v[64:67], a[160:163], a[208:211], v[64:67]
    s_cmp_eq_u32 s3, 3670016
    s_cselect_b32 s3, 0, s3
    ds_read_b128 a[212:215], v27 offset:10240
    v_mfma_f32_16x16x32_bf16 v[68:71], a[164:167], a[192:195], v[68:71]
    ds_read_b128 a[216:219], v27 offset:12288
    ds_read_b128 a[220:223], v27 offset:14336
    v_mfma_f32_16x16x32_bf16 v[72:75], a[164:167], a[196:199], v[72:75]
    ds_read_b128 a[224:227], v27 offset:16384
    ds_read_b128 a[228:231], v27 offset:18432
    v_mfma_f32_16x16x32_bf16 v[76:79], a[164:167], a[200:203], v[76:79]
    ds_read_b64_tr_b16 a[176:177], v20 offset:4096
    v_mfma_f32_16x16x32_bf16 v[80:83], a[164:167], a[204:207], v[80:83]
    ds_read_b64_tr_b16 a[178:179], v20 offset:6144
    ds_read_b64_tr_b16 a[180:181], v21 offset:4096
    v_mfma_f32_16x16x32_bf16 v[84:87], a[164:167], a[208:211], v[84:87]
    ds_read_b64_tr_b16 a[182:183], v21 offset:6144
    ds_read_b64_tr_b16 a[184:185], v22 offset:4096
    v_mfma_f32_16x16x32_bf16 v[88:91], a[168:171], a[192:195], v[88:91]
    ds_read_b64_tr_b16 a[186:187], v22 offset:6144
    ds_read_b64_tr_b16 a[188:189], v23 offset:4096
    v_mfma_f32_16x16x32_bf16 v[92:95], a[168:171], a[196:199], v[92:95]
    ds_read_b64_tr_b16 a[190:191], v23 offset:6144
    v_mfma_f32_16x16x32_bf16 v[96:99], a[168:171], a[200:203], v[96:99]
    v_mfma_f32_16x16x32_bf16 v[100:103], a[168:171], a[204:207], v[100:103]
    v_mfma_f32_16x16x32_bf16 v[104:107], a[168:171], a[208:211], v[104:107]
    v_mfma_f32_16x16x32_bf16 v[108:111], a[172:175], a[192:195], v[108:111]
    v_mfma_f32_16x16x32_bf16 v[112:115], a[172:175], a[196:199], v[112:115]
    v_mfma_f32_16x16x32_bf16 v[116:119], a[172:175], a[200:203], v[116:119]
    v_mfma_f32_16x16x32_bf16 v[120:123], a[172:175], a[204:207], v[120:123]
    v_mfma_f32_16x16x32_bf16 v[124:127], a[172:175], a[208:211], v[124:127]
    s_waitcnt lgkmcnt(0)
    v_mfma_f32_16x16x32_bf16 v[48:51], a[176:179], a[212:215], v[48:51]
    s_add_u32 m0, s33, 4096
    v_mfma_f32_16x16x32_bf16 v[52:55], a[176:179], a[216:219], v[52:55]
    s_xor_b32 s34, s100, 0
    buffer_load_dwordx4 v4, s[16:19], s34 offen offset:0 nt lds
    v_mfma_f32_16x16x32_bf16 v[56:59], a[176:179], a[220:223], v[56:59]
    buffer_load_dwordx4 v5, s[16:19], s34 offen offset:1024 nt lds
    buffer_load_dwordx4 v6, s[16:19], s34 offen offset:2048 nt lds
    v_mfma_f32_16x16x32_bf16 v[60:63], a[176:179], a[224:227], v[60:63]
    buffer_load_dwordx4 v7, s[16:19], s34 offen offset:3072 nt lds
    ds_read_b128 a[192:195], v26 offset:30720
    v_mfma_f32_16x16x32_bf16 v[64:67], a[176:179], a[228:231], v[64:67]
    ds_read_b128 a[196:199], v26 offset:32768
    ds_read_b128 a[200:203], v26 offset:34816
    v_mfma_f32_16x16x32_bf16 v[68:71], a[180:183], a[212:215], v[68:71]
    ds_read_b128 a[204:207], v26 offset:36864
    ds_read_b128 a[208:211], v26 offset:38912
    v_mfma_f32_16x16x32_bf16 v[72:75], a[180:183], a[216:219], v[72:75]
    s_waitcnt vmcnt(16)
    ds_read_b64_tr_b16 a[160:161], v20 offset:12288
    v_mfma_f32_16x16x32_bf16 v[76:79], a[180:183], a[220:223], v[76:79]
    ds_read_b64_tr_b16 a[162:163], v20 offset:14336
    ds_read_b64_tr_b16 a[164:165], v21 offset:12288
    v_mfma_f32_16x16x32_bf16 v[80:83], a[180:183], a[224:227], v[80:83]
    ds_read_b64_tr_b16 a[166:167], v21 offset:14336
    ds_read_b64_tr_b16 a[168:169], v22 offset:12288
    v_mfma_f32_16x16x32_bf16 v[84:87], a[180:183], a[228:231], v[84:87]
    ds_read_b64_tr_b16 a[170:171], v22 offset:14336
    ds_read_b64_tr_b16 a[172:173], v23 offset:12288
    v_mfma_f32_16x16x32_bf16 v[88:91], a[184:187], a[212:215], v[88:91]
    ds_read_b64_tr_b16 a[174:175], v23 offset:14336
    v_mfma_f32_16x16x32_bf16 v[92:95], a[184:187], a[216:219], v[92:95]
    v_mfma_f32_16x16x32_bf16 v[96:99], a[184:187], a[220:223], v[96:99]
    v_mfma_f32_16x16x32_bf16 v[100:103], a[184:187], a[224:227], v[100:103]
    v_mfma_f32_16x16x32_bf16 v[104:107], a[184:187], a[228:231], v[104:107]
    v_mfma_f32_16x16x32_bf16 v[108:111], a[188:191], a[212:215], v[108:111]
    v_mfma_f32_16x16x32_bf16 v[112:115], a[188:191], a[216:219], v[112:115]
    v_mfma_f32_16x16x32_bf16 v[116:119], a[188:191], a[220:223], v[116:119]
    v_mfma_f32_16x16x32_bf16 v[120:123], a[188:191], a[224:227], v[120:123]
    v_mfma_f32_16x16x32_bf16 v[124:127], a[188:191], a[228:231], v[124:127]
    s_waitcnt lgkmcnt(0)
    v_mfma_f32_16x16x32_bf16 v[48:51], a[160:163], a[192:195], v[48:51]
    s_add_u32 m0, s33, 12288
    v_mfma_f32_16x16x32_bf16 v[52:55], a[160:163], a[196:199], v[52:55]
    s_xor_b32 s34, s100, 128
    buffer_load_dwordx4 v4, s[16:19], s34 offen offset:0 nt lds
    v_mfma_f32_16x16x32_bf16 v[56:59], a[160:163], a[200:203], v[56:59]
    buffer_load_dwordx4 v5, s[16:19], s34 offen offset:1024 nt lds
    buffer_load_dwordx4 v6, s[16:19], s34 offen offset:2048 nt lds
    v_mfma_f32_16x16x32_bf16 v[60:63], a[160:163], a[204:207], v[60:63]
    buffer_load_dwordx4 v7, s[16:19], s34 offen offset:3072 nt lds
    ds_read_b128 a[212:215], v27 offset:30720
    v_mfma_f32_16x16x32_bf16 v[64:67], a[160:163], a[208:211], v[64:67]
    ds_read_b128 a[216:219], v27 offset:32768
    ds_read_b128 a[220:223], v27 offset:34816
    v_mfma_f32_16x16x32_bf16 v[68:71], a[164:167], a[192:195], v[68:71]
    ds_read_b128 a[224:227], v27 offset:36864
    ds_read_b128 a[228:231], v27 offset:38912
    v_mfma_f32_16x16x32_bf16 v[72:75], a[164:167], a[196:199], v[72:75]
    s_waitcnt vmcnt(16)
    ds_read_b64_tr_b16 a[176:177], v20 offset:8192
    v_mfma_f32_16x16x32_bf16 v[76:79], a[164:167], a[200:203], v[76:79]
    ds_read_b64_tr_b16 a[178:179], v20 offset:10240
    ds_read_b64_tr_b16 a[180:181], v21 offset:8192
    v_mfma_f32_16x16x32_bf16 v[80:83], a[164:167], a[204:207], v[80:83]
    ds_read_b64_tr_b16 a[182:183], v21 offset:10240
    ds_read_b64_tr_b16 a[184:185], v22 offset:8192
    v_mfma_f32_16x16x32_bf16 v[84:87], a[164:167], a[208:211], v[84:87]
    ds_read_b64_tr_b16 a[186:187], v22 offset:10240
    ds_read_b64_tr_b16 a[188:189], v23 offset:8192
    v_mfma_f32_16x16x32_bf16 v[88:91], a[168:171], a[192:195], v[88:91]
    ds_read_b64_tr_b16 a[190:191], v23 offset:10240
    v_mfma_f32_16x16x32_bf16 v[92:95], a[168:171], a[196:199], v[92:95]
    v_mfma_f32_16x16x32_bf16 v[96:99], a[168:171], a[200:203], v[96:99]
    v_mfma_f32_16x16x32_bf16 v[100:103], a[168:171], a[204:207], v[100:103]
    v_mfma_f32_16x16x32_bf16 v[104:107], a[168:171], a[208:211], v[104:107]
    v_mfma_f32_16x16x32_bf16 v[108:111], a[172:175], a[192:195], v[108:111]
    v_mfma_f32_16x16x32_bf16 v[112:115], a[172:175], a[196:199], v[112:115]
    v_mfma_f32_16x16x32_bf16 v[116:119], a[172:175], a[200:203], v[116:119]
    v_mfma_f32_16x16x32_bf16 v[120:123], a[172:175], a[204:207], v[120:123]
    v_mfma_f32_16x16x32_bf16 v[124:127], a[172:175], a[208:211], v[124:127]
    s_waitcnt lgkmcnt(0)
    v_mfma_f32_16x16x32_bf16 v[48:51], a[176:179], a[212:215], v[48:51]
    s_add_u32 m0, s33, 8192
    v_mfma_f32_16x16x32_bf16 v[52:55], a[176:179], a[216:219], v[52:55]
    s_xor_b32 s34, s100, 256
    buffer_load_dwordx4 v4, s[16:19], s34 offen offset:0 nt lds
    v_mfma_f32_16x16x32_bf16 v[56:59], a[176:179], a[220:223], v[56:59]
    buffer_load_dwordx4 v5, s[16:19], s34 offen offset:1024 nt lds
    buffer_load_dwordx4 v6, s[16:19], s34 offen offset:2048 nt lds
    v_mfma_f32_16x16x32_bf16 v[60:63], a[176:179], a[224:227], v[60:63]
    buffer_load_dwordx4 v7, s[16:19], s34 offen offset:3072 nt lds
    ds_read_b128 a[192:195], v28 offset:10240
    v_mfma_f32_16x16x32_bf16 v[64:67], a[176:179], a[228:231], v[64:67]
    ds_read_b128 a[196:199], v28 offset:12288
    ds_read_b128 a[200:203], v28 offset:14336
    v_mfma_f32_16x16x32_bf16 v[68:71], a[180:183], a[212:215], v[68:71]
    ds_read_b128 a[204:207], v28 offset:16384
    ds_read_b128 a[208:211], v28 offset:18432
    v_mfma_f32_16x16x32_bf16 v[72:75], a[180:183], a[216:219], v[72:75]
    s_waitcnt vmcnt(16)
    ds_read_b64_tr_b16 a[160:161], v20 offset:0
    v_mfma_f32_16x16x32_bf16 v[76:79], a[180:183], a[220:223], v[76:79]
    ds_read_b64_tr_b16 a[162:163], v20 offset:2048
    ds_read_b64_tr_b16 a[164:165], v21 offset:0
    v_mfma_f32_16x16x32_bf16 v[80:83], a[180:183], a[224:227], v[80:83]
    ds_read_b64_tr_b16 a[166:167], v21 offset:2048
    ds_read_b64_tr_b16 a[168:169], v22 offset:0
    v_mfma_f32_16x16x32_bf16 v[84:87], a[180:183], a[228:231], v[84:87]
    ds_read_b64_tr_b16 a[170:171], v22 offset:2048
    ds_read_b64_tr_b16 a[172:173], v23 offset:0
    v_mfma_f32_16x16x32_bf16 v[88:91], a[184:187], a[212:215], v[88:91]
    ds_read_b64_tr_b16 a[174:175], v23 offset:2048
    v_mfma_f32_16x16x32_bf16 v[92:95], a[184:187], a[216:219], v[92:95]
    v_mfma_f32_16x16x32_bf16 v[96:99], a[184:187], a[220:223], v[96:99]
    v_mfma_f32_16x16x32_bf16 v[100:103], a[184:187], a[224:227], v[100:103]
    v_mfma_f32_16x16x32_bf16 v[104:107], a[184:187], a[228:231], v[104:107]
    v_mfma_f32_16x16x32_bf16 v[108:111], a[188:191], a[212:215], v[108:111]
    v_mfma_f32_16x16x32_bf16 v[112:115], a[188:191], a[216:219], v[112:115]
    v_mfma_f32_16x16x32_bf16 v[116:119], a[188:191], a[220:223], v[116:119]
    v_mfma_f32_16x16x32_bf16 v[120:123], a[188:191], a[224:227], v[120:123]
    v_mfma_f32_16x16x32_bf16 v[124:127], a[188:191], a[228:231], v[124:127]
    s_waitcnt lgkmcnt(0)
    v_mfma_f32_16x16x32_bf16 v[48:51], a[160:163], a[192:195], v[48:51]
    s_add_u32 m0, s33, 0
    v_mfma_f32_16x16x32_bf16 v[52:55], a[160:163], a[196:199], v[52:55]
    s_xor_b32 s34, s100, 384
    buffer_load_dwordx4 v4, s[16:19], s34 offen offset:0 nt lds
    v_mfma_f32_16x16x32_bf16 v[56:59], a[160:163], a[200:203], v[56:59]
    buffer_load_dwordx4 v5, s[16:19], s34 offen offset:1024 nt lds
    buffer_load_dwordx4 v6, s[16:19], s34 offen offset:2048 nt lds
    v_mfma_f32_16x16x32_bf16 v[60:63], a[160:163], a[204:207], v[60:63]
    buffer_load_dwordx4 v7, s[16:19], s34 offen offset:3072 nt lds
    ds_read_b128 a[212:215], v29 offset:10240
    v_mfma_f32_16x16x32_bf16 v[64:67], a[160:163], a[208:211], v[64:67]
    ds_read_b128 a[216:219], v29 offset:12288
    ds_read_b128 a[220:223], v29 offset:14336
    v_mfma_f32_16x16x32_bf16 v[68:71], a[164:167], a[192:195], v[68:71]
    ds_read_b128 a[224:227], v29 offset:16384
    ds_read_b128 a[228:231], v29 offset:18432
    v_mfma_f32_16x16x32_bf16 v[72:75], a[164:167], a[196:199], v[72:75]
    s_waitcnt vmcnt(16)
    ds_read_b64_tr_b16 a[176:177], v20 offset:16384
    v_mfma_f32_16x16x32_bf16 v[76:79], a[164:167], a[200:203], v[76:79]
    ds_read_b64_tr_b16 a[178:179], v20 offset:18432
    ds_read_b64_tr_b16 a[180:181], v21 offset:16384
    v_mfma_f32_16x16x32_bf16 v[80:83], a[164:167], a[204:207], v[80:83]
    ds_read_b64_tr_b16 a[182:183], v21 offset:18432
    ds_read_b64_tr_b16 a[184:185], v22 offset:16384
    v_mfma_f32_16x16x32_bf16 v[84:87], a[164:167], a[208:211], v[84:87]
    ds_read_b64_tr_b16 a[186:187], v22 offset:18432
    ds_read_b64_tr_b16 a[188:189], v23 offset:16384
    v_mfma_f32_16x16x32_bf16 v[88:91], a[168:171], a[192:195], v[88:91]
    ds_read_b64_tr_b16 a[190:191], v23 offset:18432
    v_mfma_f32_16x16x32_bf16 v[92:95], a[168:171], a[196:199], v[92:95]
    v_mfma_f32_16x16x32_bf16 v[96:99], a[168:171], a[200:203], v[96:99]
    v_mfma_f32_16x16x32_bf16 v[100:103], a[168:171], a[204:207], v[100:103]
    v_mfma_f32_16x16x32_bf16 v[104:107], a[168:171], a[208:211], v[104:107]
    v_mfma_f32_16x16x32_bf16 v[108:111], a[172:175], a[192:195], v[108:111]
    v_mfma_f32_16x16x32_bf16 v[112:115], a[172:175], a[196:199], v[112:115]
    v_mfma_f32_16x16x32_bf16 v[116:119], a[172:175], a[200:203], v[116:119]
    v_mfma_f32_16x16x32_bf16 v[120:123], a[172:175], a[204:207], v[120:123]
    v_mfma_f32_16x16x32_bf16 v[124:127], a[172:175], a[208:211], v[124:127]
    s_waitcnt lgkmcnt(0)
    v_mfma_f32_16x16x32_bf16 v[48:51], a[176:179], a[212:215], v[48:51]
    s_add_u32 m0, s33, 16384
    s_xor_b32 s34, s100, 16384
    v_mfma_f32_16x16x32_bf16 v[52:55], a[176:179], a[216:219], v[52:55]
    buffer_load_dwordx4 v4, s[16:19], s34 offen offset:0 nt lds
    buffer_load_dwordx4 v5, s[16:19], s34 offen offset:1024 nt lds
    buffer_load_dwordx4 v6, s[16:19], s34 offen offset:2048 nt lds
    v_mfma_f32_16x16x32_bf16 v[56:59], a[176:179], a[220:223], v[56:59]
    buffer_load_dwordx4 v7, s[16:19], s34 offen offset:3072 nt lds
    s_waitcnt vmcnt(16)
    ds_read_b128 a[120:123], v24 offset:4096
    v_mfma_f32_16x16x32_bf16 v[60:63], a[176:179], a[224:227], v[60:63]
    ds_read_b128 a[124:127], v24 offset:6144
    ds_read_b128 a[128:131], v25 offset:4096
    ds_read_b128 a[132:135], v25 offset:6144
    v_mfma_f32_16x16x32_bf16 v[64:67], a[176:179], a[228:231], v[64:67]
    v_mfma_f32_16x16x32_bf16 v[68:71], a[180:183], a[212:215], v[68:71]
    v_mfma_f32_16x16x32_bf16 v[72:75], a[180:183], a[216:219], v[72:75]
    v_mfma_f32_16x16x32_bf16 v[76:79], a[180:183], a[220:223], v[76:79]
    v_mfma_f32_16x16x32_bf16 v[80:83], a[180:183], a[224:227], v[80:83]
    v_mfma_f32_16x16x32_bf16 v[84:87], a[180:183], a[228:231], v[84:87]
    v_mfma_f32_16x16x32_bf16 v[88:91], a[184:187], a[212:215], v[88:91]
    v_cvt_pk_bf16_f32 v40, v48, v49
    v_cvt_pk_bf16_f32 v41, v50, v51
    v_cvt_pk_bf16_f32 v42, v52, v53
    v_mfma_f32_16x16x32_bf16 v[92:95], a[184:187], a[216:219], v[92:95]
    v_cvt_pk_bf16_f32 v43, v54, v55
    v_cvt_pk_bf16_f32 v44, v56, v57
    ds_write_b64 v30, v[40:41] offset:0
    v_mfma_f32_16x16x32_bf16 v[96:99], a[184:187], a[220:223], v[96:99]
    v_cvt_pk_bf16_f32 v45, v58, v59
    v_cvt_pk_bf16_f32 v46, v60, v61
    ds_write_b64 v30, v[42:43] offset:1024
    v_mfma_f32_16x16x32_bf16 v[100:103], a[184:187], a[224:227], v[100:103]
    v_cvt_pk_bf16_f32 v47, v62, v63
    v_cvt_pk_bf16_f32 v40, v64, v65
    ds_write_b64 v30, v[44:45] offset:2048
    v_mfma_f32_16x16x32_bf16 v[104:107], a[184:187], a[228:231], v[104:107]
    v_cvt_pk_bf16_f32 v41, v66, v67
    v_cvt_pk_bf16_f32 v42, v68, v69
    ds_write_b64 v30, v[46:47] offset:3072
    v_mfma_f32_16x16x32_bf16 v[108:111], a[188:191], a[212:215], v[108:111]
    v_cvt_pk_bf16_f32 v43, v70, v71
    v_cvt_pk_bf16_f32 v44, v72, v73
    ds_write_b64 v30, v[40:41] offset:4096
    v_mfma_f32_16x16x32_bf16 v[112:115], a[188:191], a[216:219], v[112:115]
    v_cvt_pk_bf16_f32 v45, v74, v75
    v_cvt_pk_bf16_f32 v46, v76, v77
    ds_write_b64 v30, v[42:43] offset:512
    v_mfma_f32_16x16x32_bf16 v[116:119], a[188:191], a[220:223], v[116:119]
    v_cvt_pk_bf16_f32 v47, v78, v79
    v_cvt_pk_bf16_f32 v40, v80, v81
    ds_write_b64 v30, v[44:45] offset:1536
    v_mfma_f32_16x16x32_bf16 v[120:123], a[188:191], a[224:227], v[120:123]
    v_cvt_pk_bf16_f32 v41, v82, v83
    v_cvt_pk_bf16_f32 v42, v84, v85
    ds_write_b64 v30, v[46:47] offset:2560
    v_mfma_f32_16x16x32_bf16 v[124:127], a[188:191], a[228:231], v[124:127]
    v_cvt_pk_bf16_f32 v43, v86, v87
    v_cvt_pk_bf16_f32 v44, v88, v89
    ds_write_b64 v30, v[40:41] offset:3584
    v_cvt_pk_bf16_f32 v45, v90, v91
    v_cvt_pk_bf16_f32 v46, v92, v93
    ds_write_b64 v30, v[42:43] offset:4608
    v_cvt_pk_bf16_f32 v47, v94, v95
    v_cvt_pk_bf16_f32 v40, v96, v97
    ds_write_b64 v30, v[44:45] offset:5120
    v_cvt_pk_bf16_f32 v41, v98, v99
    v_cvt_pk_bf16_f32 v42, v100, v101
    ds_write_b64 v30, v[46:47] offset:6144
    v_cvt_pk_bf16_f32 v43, v102, v103
    v_cvt_pk_bf16_f32 v44, v104, v105
    ds_write_b64 v30, v[40:41] offset:7168
    v_cvt_pk_bf16_f32 v45, v106, v107
    v_cvt_pk_bf16_f32 v46, v108, v109
    ds_write_b64 v30, v[42:43] offset:8192
    v_cvt_pk_bf16_f32 v47, v110, v111
    v_cvt_pk_bf16_f32 v40, v112, v113
    ds_write_b64 v30, v[44:45] offset:9216
    v_cvt_pk_bf16_f32 v41, v114, v115
    v_cvt_pk_bf16_f32 v42, v116, v117
    ds_write_b64 v30, v[46:47] offset:5632
    v_cvt_pk_bf16_f32 v43, v118, v119
    v_cvt_pk_bf16_f32 v44, v120, v121
    ds_write_b64 v30, v[40:41] offset:6656
    v_cvt_pk_bf16_f32 v45, v122, v123
    v_cvt_pk_bf16_f32 v46, v124, v125
    ds_write_b64 v30, v[42:43] offset:7680
    v_cvt_pk_bf16_f32 v47, v126, v127
    ds_write_b64 v30, v[44:45] offset:8704
    ds_write_b64 v30, v[46:47] offset:9728
    s_waitcnt lgkmcnt(15)
    s_add_u32 m0, s33, 4096
    s_xor_b32 s34, s100, 16512
    buffer_load_dwordx4 v4, s[16:19], s34 offen offset:0 nt lds
    buffer_load_dwordx4 v5, s[16:19], s34 offen offset:1024 nt lds
    buffer_load_dwordx4 v6, s[16:19], s34 offen offset:2048 nt lds
    buffer_load_dwordx4 v7, s[16:19], s34 offen offset:3072 nt lds
    s_waitcnt vmcnt(16)
    ds_read_b128 a[136:139], v24 offset:12288
    ds_read_b128 a[140:143], v24 offset:14336
    ds_read_b128 a[144:147], v25 offset:12288
    ds_read_b128 a[148:151], v25 offset:14336
    s_waitcnt lgkmcnt(0)
    s_barrier
    v_subrev_u32 v26, 81920, v20
    v_subrev_u32 v27, 81920, v21
    v_subrev_u32 v28, 81920, v22
    v_subrev_u32 v29, 81920, v23
    ds_read_b128 a[0:3], v1 offset:0
    ds_read_b128 a[4:7], v1 offset:1024
    ds_read_b128 a[8:11], v1 offset:2048
    ds_read_b128 a[12:15], v1 offset:3072
    ds_read_b128 a[16:19], v1 offset:4096
    ds_read_b128 a[20:23], v1 offset:5120
    ds_read_b128 a[24:27], v1 offset:6144
    ds_read_b128 a[28:31], v1 offset:7168
    ds_read_b128 a[32:35], v1 offset:8192
    ds_read_b128 a[36:39], v1 offset:9216
    s_add_u32 m0, s33, 12288
    s_xor_b32 s34, s100, 16640
    buffer_load_dwordx4 v4, s[16:19], s34 offen offset:0 nt lds
    buffer_load_dwordx4 v5, s[16:19], s34 offen offset:1024 nt lds
    buffer_load_dwordx4 v6, s[16:19], s34 offen offset:2048 nt lds
    buffer_load_dwordx4 v7, s[16:19], s34 offen offset:3072 nt lds
    s_waitcnt vmcnt(16)
    ds_read_b128 v[208:211], v24 offset:8192
    ds_read_b128 v[212:215], v24 offset:10240
    ds_read_b128 v[216:219], v25 offset:8192
    ds_read_b128 v[220:223], v25 offset:10240
    s_waitcnt lgkmcnt(4)
    v_mfma_f32_16x16x32_bf16 v[48:51], a[120:123], a[0:3], 0
    ds_read_b128 a[40:43], v1 offset:20480
    ds_read_b128 a[44:47], v1 offset:21504
    v_mfma_f32_16x16x32_bf16 v[52:55], a[120:123], a[4:7], 0
    ds_read_b128 a[48:51], v1 offset:22528
    ds_read_b128 a[52:55], v1 offset:23552
    v_mfma_f32_16x16x32_bf16 v[56:59], a[120:123], a[8:11], 0
    ds_read_b128 a[56:59], v1 offset:24576
    ds_read_b128 a[60:63], v1 offset:25600
    v_mfma_f32_16x16x32_bf16 v[60:63], a[120:123], a[12:15], 0
    ds_read_b128 a[64:67], v1 offset:26624
    ds_read_b128 a[68:71], v1 offset:27648
    v_mfma_f32_16x16x32_bf16 v[64:67], a[120:123], a[16:19], 0
    ds_read_b128 a[72:75], v1 offset:28672
    ds_read_b128 a[76:79], v1 offset:29696
    v_mfma_f32_16x16x32_bf16 v[68:71], a[124:127], a[0:3], 0
    s_waitcnt lgkmcnt(10)
    s_add_u32 m0, s33, 8192
    v_mfma_f32_16x16x32_bf16 v[72:75], a[124:127], a[4:7], 0
    s_xor_b32 s34, s100, 16768
    buffer_load_dwordx4 v4, s[16:19], s34 offen offset:0 nt lds
    v_mfma_f32_16x16x32_bf16 v[76:79], a[124:127], a[8:11], 0
    buffer_load_dwordx4 v5, s[16:19], s34 offen offset:1024 nt lds
    buffer_load_dwordx4 v6, s[16:19], s34 offen offset:2048 nt lds
    v_mfma_f32_16x16x32_bf16 v[80:83], a[124:127], a[12:15], 0
    buffer_load_dwordx4 v7, s[16:19], s34 offen offset:3072 nt lds
    s_waitcnt vmcnt(16)
    v_mfma_f32_16x16x32_bf16 v[84:87], a[124:127], a[16:19], 0
    ds_read_b128 v[224:227], v24 offset:0
    ds_read_b128 v[228:231], v24 offset:2048
    v_mfma_f32_16x16x32_bf16 v[48:51], a[128:131], a[20:23], v[48:51]
    ds_read_b128 v[232:235], v25 offset:0
    ds_read_b128 v[236:239], v25 offset:2048
    v_mfma_f32_16x16x32_bf16 v[52:55], a[128:131], a[24:27], v[52:55]
    v_mfma_f32_16x16x32_bf16 v[56:59], a[128:131], a[28:31], v[56:59]
    v_mfma_f32_16x16x32_bf16 v[60:63], a[128:131], a[32:35], v[60:63]
    v_mfma_f32_16x16x32_bf16 v[64:67], a[128:131], a[36:39], v[64:67]
    v_mfma_f32_16x16x32_bf16 v[68:71], a[132:135], a[20:23], v[68:71]
    v_mfma_f32_16x16x32_bf16 v[72:75], a[132:135], a[24:27], v[72:75]
    v_mfma_f32_16x16x32_bf16 v[76:79], a[132:135], a[28:31], v[76:79]
    v_mfma_f32_16x16x32_bf16 v[80:83], a[132:135], a[32:35], v[80:83]
    v_mfma_f32_16x16x32_bf16 v[84:87], a[132:135], a[36:39], v[84:87]
    s_waitcnt lgkmcnt(4)
    v_mfma_f32_16x16x32_bf16 v[48:51], a[136:139], a[40:43], v[48:51]
    ds_read_b128 a[80:83], v2 offset:0
    ds_read_b128 a[84:87], v2 offset:1024
    v_mfma_f32_16x16x32_bf16 v[52:55], a[136:139], a[44:47], v[52:55]
    ds_read_b128 a[88:91], v2 offset:2048
    ds_read_b128 a[92:95], v2 offset:3072
    v_mfma_f32_16x16x32_bf16 v[56:59], a[136:139], a[48:51], v[56:59]
    ds_read_b128 a[96:99], v2 offset:4096
    ds_read_b128 a[100:103], v2 offset:5120
    v_mfma_f32_16x16x32_bf16 v[60:63], a[136:139], a[52:55], v[60:63]
    ds_read_b128 a[104:107], v2 offset:6144
    ds_read_b128 a[108:111], v2 offset:7168
    v_mfma_f32_16x16x32_bf16 v[64:67], a[136:139], a[56:59], v[64:67]
    ds_read_b128 a[112:115], v2 offset:8192
    ds_read_b128 a[116:119], v2 offset:9216
    v_mfma_f32_16x16x32_bf16 v[68:71], a[140:143], a[40:43], v[68:71]
    s_waitcnt lgkmcnt(10)
    s_add_u32 m0, s33, 0
    v_mfma_f32_16x16x32_bf16 v[72:75], a[140:143], a[44:47], v[72:75]
    s_xor_b32 s34, s100, 32768
    buffer_load_dwordx4 v4, s[16:19], s34 offen offset:0 nt lds
    v_mfma_f32_16x16x32_bf16 v[76:79], a[140:143], a[48:51], v[76:79]
    buffer_load_dwordx4 v5, s[16:19], s34 offen offset:1024 nt lds
    buffer_load_dwordx4 v6, s[16:19], s34 offen offset:2048 nt lds
    v_mfma_f32_16x16x32_bf16 v[80:83], a[140:143], a[52:55], v[80:83]
    buffer_load_dwordx4 v7, s[16:19], s34 offen offset:3072 nt lds
    s_waitcnt vmcnt(16)
    v_mfma_f32_16x16x32_bf16 v[84:87], a[140:143], a[56:59], v[84:87]
    ds_read_b128 v[128:131], v24 offset:16384
    ds_read_b128 v[132:135], v24 offset:18432
    v_mfma_f32_16x16x32_bf16 v[48:51], a[144:147], a[60:63], v[48:51]
    ds_read_b128 v[136:139], v25 offset:16384
    ds_read_b128 v[140:143], v25 offset:18432
    v_mfma_f32_16x16x32_bf16 v[52:55], a[144:147], a[64:67], v[52:55]
    v_mfma_f32_16x16x32_bf16 v[56:59], a[144:147], a[68:71], v[56:59]
    v_mfma_f32_16x16x32_bf16 v[60:63], a[144:147], a[72:75], v[60:63]
    v_mfma_f32_16x16x32_bf16 v[64:67], a[144:147], a[76:79], v[64:67]
    v_mfma_f32_16x16x32_bf16 v[68:71], a[148:151], a[60:63], v[68:71]
    v_mfma_f32_16x16x32_bf16 v[72:75], a[148:151], a[64:67], v[72:75]
    v_mfma_f32_16x16x32_bf16 v[76:79], a[148:151], a[68:71], v[76:79]
    v_mfma_f32_16x16x32_bf16 v[80:83], a[148:151], a[72:75], v[80:83]
    v_mfma_f32_16x16x32_bf16 v[84:87], a[148:151], a[76:79], v[84:87]
    s_waitcnt lgkmcnt(4)
    v_mfma_f32_16x16x32_bf16 v[48:51], v[208:211], a[80:83], v[48:51]
    ds_read_b128 a[120:123], v2 offset:20480
    ds_read_b128 a[124:127], v2 offset:21504
    v_mfma_f32_16x16x32_bf16 v[52:55], v[208:211], a[84:87], v[52:55]
    ds_read_b128 a[128:131], v2 offset:22528
    ds_read_b128 a[132:135], v2 offset:23552
    v_mfma_f32_16x16x32_bf16 v[56:59], v[208:211], a[88:91], v[56:59]
    ds_read_b128 a[136:139], v2 offset:24576
    ds_read_b128 a[140:143], v2 offset:25600
    v_mfma_f32_16x16x32_bf16 v[60:63], v[208:211], a[92:95], v[60:63]
    ds_read_b128 a[144:147], v2 offset:26624
    ds_read_b128 a[148:151], v2 offset:27648
    v_mfma_f32_16x16x32_bf16 v[64:67], v[208:211], a[96:99], v[64:67]
    ds_read_b128 a[152:155], v2 offset:28672
    ds_read_b128 a[156:159], v2 offset:29696
    v_mfma_f32_16x16x32_bf16 v[68:71], v[212:215], a[80:83], v[68:71]
    s_waitcnt lgkmcnt(10)
    s_add_u32 m0, s33, 16384
    v_mfma_f32_16x16x32_bf16 v[72:75], v[212:215], a[84:87], v[72:75]
    s_xor_b32 s34, s100, 32896
    buffer_load_dwordx4 v4, s[16:19], s34 offen offset:0 nt lds
    v_mfma_f32_16x16x32_bf16 v[76:79], v[212:215], a[88:91], v[76:79]
    buffer_load_dwordx4 v5, s[16:19], s34 offen offset:1024 nt lds
    buffer_load_dwordx4 v6, s[16:19], s34 offen offset:2048 nt lds
    v_mfma_f32_16x16x32_bf16 v[80:83], v[212:215], a[92:95], v[80:83]
    buffer_load_dwordx4 v7, s[16:19], s34 offen offset:3072 nt lds
    s_waitcnt vmcnt(16)
    v_mfma_f32_16x16x32_bf16 v[84:87], v[212:215], a[96:99], v[84:87]
    ds_read_b128 v[144:147], v24 offset:4096
    ds_read_b128 v[148:151], v24 offset:6144
    v_mfma_f32_16x16x32_bf16 v[48:51], v[216:219], a[100:103], v[48:51]
    ds_read_b128 v[152:155], v25 offset:4096
    ds_read_b128 v[156:159], v25 offset:6144
    v_mfma_f32_16x16x32_bf16 v[52:55], v[216:219], a[104:107], v[52:55]
    v_mfma_f32_16x16x32_bf16 v[56:59], v[216:219], a[108:111], v[56:59]
    v_mfma_f32_16x16x32_bf16 v[60:63], v[216:219], a[112:115], v[60:63]
    v_mfma_f32_16x16x32_bf16 v[64:67], v[216:219], a[116:119], v[64:67]
    v_mfma_f32_16x16x32_bf16 v[68:71], v[220:223], a[100:103], v[68:71]
    v_mfma_f32_16x16x32_bf16 v[72:75], v[220:223], a[104:107], v[72:75]
    v_mfma_f32_16x16x32_bf16 v[76:79], v[220:223], a[108:111], v[76:79]
    v_mfma_f32_16x16x32_bf16 v[80:83], v[220:223], a[112:115], v[80:83]
    v_mfma_f32_16x16x32_bf16 v[84:87], v[220:223], a[116:119], v[84:87]
    s_waitcnt lgkmcnt(4)
    v_mfma_f32_16x16x32_bf16 v[48:51], v[224:227], a[120:123], v[48:51]
    s_waitcnt lgkmcnt(0)
    s_add_u32 m0, s33, 4096
    v_mfma_f32_16x16x32_bf16 v[52:55], v[224:227], a[124:127], v[52:55]
    s_xor_b32 s34, s100, 33024
    buffer_load_dwordx4 v4, s[16:19], s34 offen offset:0 nt lds
    v_mfma_f32_16x16x32_bf16 v[56:59], v[224:227], a[128:131], v[56:59]
    buffer_load_dwordx4 v5, s[16:19], s34 offen offset:1024 nt lds
    buffer_load_dwordx4 v6, s[16:19], s34 offen offset:2048 nt lds
    v_mfma_f32_16x16x32_bf16 v[60:63], v[224:227], a[132:135], v[60:63]
    buffer_load_dwordx4 v7, s[16:19], s34 offen offset:3072 nt lds
    s_waitcnt vmcnt(16)
    v_mfma_f32_16x16x32_bf16 v[64:67], v[224:227], a[136:139], v[64:67]
    ds_read_b128 v[160:163], v24 offset:12288
    ds_read_b128 v[164:167], v24 offset:14336
    v_mfma_f32_16x16x32_bf16 v[68:71], v[228:231], a[120:123], v[68:71]
    ds_read_b128 v[168:171], v25 offset:12288
    ds_read_b128 v[172:175], v25 offset:14336
    v_mfma_f32_16x16x32_bf16 v[72:75], v[228:231], a[124:127], v[72:75]
    v_mfma_f32_16x16x32_bf16 v[76:79], v[228:231], a[128:131], v[76:79]
    v_mfma_f32_16x16x32_bf16 v[80:83], v[228:231], a[132:135], v[80:83]
    v_mfma_f32_16x16x32_bf16 v[84:87], v[228:231], a[136:139], v[84:87]
    v_mfma_f32_16x16x32_bf16 v[48:51], v[232:235], a[140:143], v[48:51]
    v_mfma_f32_16x16x32_bf16 v[52:55], v[232:235], a[144:147], v[52:55]
    v_mfma_f32_16x16x32_bf16 v[56:59], v[232:235], a[148:151], v[56:59]
    v_mfma_f32_16x16x32_bf16 v[60:63], v[232:235], a[152:155], v[60:63]
    v_mfma_f32_16x16x32_bf16 v[64:67], v[232:235], a[156:159], v[64:67]
    v_mfma_f32_16x16x32_bf16 v[68:71], v[236:239], a[140:143], v[68:71]
    v_mfma_f32_16x16x32_bf16 v[72:75], v[236:239], a[144:147], v[72:75]
    v_mfma_f32_16x16x32_bf16 v[76:79], v[236:239], a[148:151], v[76:79]
    v_mfma_f32_16x16x32_bf16 v[80:83], v[236:239], a[152:155], v[80:83]
    v_mfma_f32_16x16x32_bf16 v[84:87], v[236:239], a[156:159], v[84:87]
    s_barrier
    v_mfma_f32_16x16x32_bf16 v[88:91], v[128:131], a[0:3], 0
    s_waitcnt lgkmcnt(0)
    s_add_u32 m0, s33, 12288
    v_mfma_f32_16x16x32_bf16 v[92:95], v[128:131], a[4:7], 0
    s_xor_b32 s34, s100, 33152
    buffer_load_dwordx4 v4, s[16:19], s34 offen offset:0 nt lds
    v_mfma_f32_16x16x32_bf16 v[96:99], v[128:131], a[8:11], 0
    buffer_load_dwordx4 v5, s[16:19], s34 offen offset:1024 nt lds
    buffer_load_dwordx4 v6, s[16:19], s34 offen offset:2048 nt lds
    v_mfma_f32_16x16x32_bf16 v[100:103], v[128:131], a[12:15], 0
    buffer_load_dwordx4 v7, s[16:19], s34 offen offset:3072 nt lds
    s_waitcnt vmcnt(16)
    v_mfma_f32_16x16x32_bf16 v[104:107], v[128:131], a[16:19], 0
    ds_read_b128 v[176:179], v24 offset:8192
    ds_read_b128 v[180:183], v24 offset:10240
    v_mfma_f32_16x16x32_bf16 v[108:111], v[132:135], a[0:3], 0
    ds_read_b128 v[184:187], v25 offset:8192
    ds_read_b128 v[188:191], v25 offset:10240
    v_mfma_f32_16x16x32_bf16 v[112:115], v[132:135], a[4:7], 0
    v_max3_f32 v248, v48, v49, v50
    v_max3_f32 v249, v51, v68, v69
    v_mfma_f32_16x16x32_bf16 v[116:119], v[132:135], a[8:11], 0
    v_max3_f32 v248, v248, v70, v71
    v_max_f32 v40, v248, v249
    v_mfma_f32_16x16x32_bf16 v[120:123], v[132:135], a[12:15], 0
    v_max3_f32 v250, v52, v53, v54
    v_mfma_f32_16x16x32_bf16 v[124:127], v[132:135], a[16:19], 0
    v_mfma_f32_16x16x32_bf16 v[88:91], v[136:139], a[20:23], v[88:91]
    v_mfma_f32_16x16x32_bf16 v[92:95], v[136:139], a[24:27], v[92:95]
    v_mfma_f32_16x16x32_bf16 v[96:99], v[136:139], a[28:31], v[96:99]
    v_mfma_f32_16x16x32_bf16 v[100:103], v[136:139], a[32:35], v[100:103]
    v_mfma_f32_16x16x32_bf16 v[104:107], v[136:139], a[36:39], v[104:107]
    v_mfma_f32_16x16x32_bf16 v[108:111], v[140:143], a[20:23], v[108:111]
    v_mfma_f32_16x16x32_bf16 v[112:115], v[140:143], a[24:27], v[112:115]
    v_mfma_f32_16x16x32_bf16 v[116:119], v[140:143], a[28:31], v[116:119]
    v_mfma_f32_16x16x32_bf16 v[120:123], v[140:143], a[32:35], v[120:123]
    v_mfma_f32_16x16x32_bf16 v[124:127], v[140:143], a[36:39], v[124:127]
    v_mfma_f32_16x16x32_bf16 v[88:91], v[144:147], a[40:43], v[88:91]
    s_waitcnt lgkmcnt(0)
    s_add_u32 m0, s33, 8192
    v_mfma_f32_16x16x32_bf16 v[92:95], v[144:147], a[44:47], v[92:95]
    s_xor_b32 s34, s100, 49152
    buffer_load_dwordx4 v4, s[16:19], s34 offen offset:0 nt lds
    v_mfma_f32_16x16x32_bf16 v[96:99], v[144:147], a[48:51], v[96:99]
    buffer_load_dwordx4 v5, s[16:19], s34 offen offset:1024 nt lds
    buffer_load_dwordx4 v6, s[16:19], s34 offen offset:2048 nt lds
    v_mfma_f32_16x16x32_bf16 v[100:103], v[144:147], a[52:55], v[100:103]
    buffer_load_dwordx4 v7, s[16:19], s34 offen offset:3072 nt lds
    s_waitcnt vmcnt(16)
    v_mfma_f32_16x16x32_bf16 v[104:107], v[144:147], a[56:59], v[104:107]
    ds_read_b128 v[192:195], v24 offset:0
    ds_read_b128 v[196:199], v24 offset:2048
    v_mfma_f32_16x16x32_bf16 v[108:111], v[148:151], a[40:43], v[108:111]
    ds_read_b128 v[200:203], v25 offset:0
    ds_read_b128 v[204:207], v25 offset:2048
    v_mfma_f32_16x16x32_bf16 v[112:115], v[148:151], a[44:47], v[112:115]
    v_max3_f32 v251, v55, v72, v73
    v_max3_f32 v250, v250, v74, v75
    v_mfma_f32_16x16x32_bf16 v[116:119], v[148:151], a[48:51], v[116:119]
    v_max_f32 v41, v250, v251
    v_max3_f32 v248, v56, v57, v58
    v_mfma_f32_16x16x32_bf16 v[120:123], v[148:151], a[52:55], v[120:123]
    v_max3_f32 v249, v59, v76, v77
    v_mov_b32 v46, 0x3f803f80
    v_mfma_f32_16x16x32_bf16 v[124:127], v[148:151], a[56:59], v[124:127]
    v_accvgpr_write_b32 a252, v46
    v_accvgpr_write_b32 a253, v46
    v_mfma_f32_16x16x32_bf16 v[88:91], v[152:155], a[60:63], v[88:91]
    v_accvgpr_write_b32 a254, v46
    v_accvgpr_write_b32 a255, v46
    v_mfma_f32_16x16x32_bf16 v[92:95], v[152:155], a[64:67], v[92:95]
    v_mfma_f32_16x16x32_bf16 v[96:99], v[152:155], a[68:71], v[96:99]
    v_mfma_f32_16x16x32_bf16 v[100:103], v[152:155], a[72:75], v[100:103]
    v_mfma_f32_16x16x32_bf16 v[104:107], v[152:155], a[76:79], v[104:107]
    v_mfma_f32_16x16x32_bf16 v[108:111], v[156:159], a[60:63], v[108:111]
    v_mfma_f32_16x16x32_bf16 v[112:115], v[156:159], a[64:67], v[112:115]
    v_mfma_f32_16x16x32_bf16 v[116:119], v[156:159], a[68:71], v[116:119]
    v_mfma_f32_16x16x32_bf16 v[120:123], v[156:159], a[72:75], v[120:123]
    v_mfma_f32_16x16x32_bf16 v[124:127], v[156:159], a[76:79], v[124:127]
    v_mfma_f32_16x16x32_bf16 v[88:91], v[160:163], a[80:83], v[88:91]
    s_waitcnt lgkmcnt(0)
    s_add_u32 m0, s33, 0
    v_mfma_f32_16x16x32_bf16 v[92:95], v[160:163], a[84:87], v[92:95]
    s_xor_b32 s34, s100, 49280
    buffer_load_dwordx4 v4, s[16:19], s34 offen offset:0 nt lds
    v_mfma_f32_16x16x32_bf16 v[96:99], v[160:163], a[88:91], v[96:99]
    buffer_load_dwordx4 v5, s[16:19], s34 offen offset:1024 nt lds
    buffer_load_dwordx4 v6, s[16:19], s34 offen offset:2048 nt lds
    v_mfma_f32_16x16x32_bf16 v[100:103], v[160:163], a[92:95], v[100:103]
    buffer_load_dwordx4 v7, s[16:19], s34 offen offset:3072 nt lds
    s_waitcnt vmcnt(16)
    v_mfma_f32_16x16x32_bf16 v[104:107], v[160:163], a[96:99], v[104:107]
    ds_read_b128 a[232:235], v24 offset:16384
    ds_read_b128 a[236:239], v24 offset:18432
    v_mfma_f32_16x16x32_bf16 v[108:111], v[164:167], a[80:83], v[108:111]
    ds_read_b128 a[240:243], v25 offset:16384
    ds_read_b128 a[244:247], v25 offset:18432
    v_mfma_f32_16x16x32_bf16 v[112:115], v[164:167], a[84:87], v[112:115]
    v_max3_f32 v248, v248, v78, v79
    v_max_f32 v42, v248, v249
    v_mfma_f32_16x16x32_bf16 v[116:119], v[164:167], a[88:91], v[116:119]
    v_max3_f32 v250, v60, v61, v62
    v_max3_f32 v251, v63, v80, v81
    v_mfma_f32_16x16x32_bf16 v[120:123], v[164:167], a[92:95], v[120:123]
    v_max3_f32 v250, v250, v82, v83
    v_mfma_f32_16x16x32_bf16 v[124:127], v[164:167], a[96:99], v[124:127]
    v_mfma_f32_16x16x32_bf16 v[88:91], v[168:171], a[100:103], v[88:91]
    v_mfma_f32_16x16x32_bf16 v[92:95], v[168:171], a[104:107], v[92:95]
    v_mfma_f32_16x16x32_bf16 v[96:99], v[168:171], a[108:111], v[96:99]
    v_mfma_f32_16x16x32_bf16 v[100:103], v[168:171], a[112:115], v[100:103]
    v_mfma_f32_16x16x32_bf16 v[104:107], v[168:171], a[116:119], v[104:107]
    v_mfma_f32_16x16x32_bf16 v[108:111], v[172:175], a[100:103], v[108:111]
    v_mfma_f32_16x16x32_bf16 v[112:115], v[172:175], a[104:107], v[112:115]
    v_mfma_f32_16x16x32_bf16 v[116:119], v[172:175], a[108:111], v[116:119]
    v_mfma_f32_16x16x32_bf16 v[120:123], v[172:175], a[112:115], v[120:123]
    v_mfma_f32_16x16x32_bf16 v[124:127], v[172:175], a[116:119], v[124:127]
    v_mfma_f32_16x16x32_bf16 v[88:91], v[176:179], a[120:123], v[88:91]
    s_waitcnt lgkmcnt(0)
    s_add_u32 m0, s33, 16384
    v_mfma_f32_16x16x32_bf16 v[92:95], v[176:179], a[124:127], v[92:95]
    s_xor_b32 s34, s100, 49408
    buffer_load_dwordx4 v4, s[16:19], s34 offen offset:0 nt lds
    v_mfma_f32_16x16x32_bf16 v[96:99], v[176:179], a[128:131], v[96:99]
    buffer_load_dwordx4 v5, s[16:19], s34 offen offset:1024 nt lds
    buffer_load_dwordx4 v6, s[16:19], s34 offen offset:2048 nt lds
    v_mfma_f32_16x16x32_bf16 v[100:103], v[176:179], a[132:135], v[100:103]
    buffer_load_dwordx4 v7, s[16:19], s34 offen offset:3072 nt lds
    s_waitcnt vmcnt(16)
    v_mfma_f32_16x16x32_bf16 v[104:107], v[176:179], a[136:139], v[104:107]
    ds_read_b128 a[192:195], v24 offset:4096
    ds_read_b128 a[196:199], v24 offset:6144
    v_mfma_f32_16x16x32_bf16 v[108:111], v[180:183], a[120:123], v[108:111]
    ds_read_b128 a[200:203], v25 offset:4096
    ds_read_b128 a[204:207], v25 offset:6144
    v_mfma_f32_16x16x32_bf16 v[112:115], v[180:183], a[124:127], v[112:115]
    v_max_f32 v43, v250, v251
    v_max3_f32 v248, v64, v65, v66
    v_mfma_f32_16x16x32_bf16 v[116:119], v[180:183], a[128:131], v[116:119]
    v_max3_f32 v249, v67, v84, v85
    v_max3_f32 v248, v248, v86, v87
    v_mfma_f32_16x16x32_bf16 v[120:123], v[180:183], a[132:135], v[120:123]
    v_max_f32 v44, v248, v249
    v_mfma_f32_16x16x32_bf16 v[124:127], v[180:183], a[136:139], v[124:127]
    v_mfma_f32_16x16x32_bf16 v[88:91], v[184:187], a[140:143], v[88:91]
    v_mfma_f32_16x16x32_bf16 v[92:95], v[184:187], a[144:147], v[92:95]
    v_mfma_f32_16x16x32_bf16 v[96:99], v[184:187], a[148:151], v[96:99]
    v_mfma_f32_16x16x32_bf16 v[100:103], v[184:187], a[152:155], v[100:103]
    v_mfma_f32_16x16x32_bf16 v[104:107], v[184:187], a[156:159], v[104:107]
    v_mfma_f32_16x16x32_bf16 v[108:111], v[188:191], a[140:143], v[108:111]
    v_mfma_f32_16x16x32_bf16 v[112:115], v[188:191], a[144:147], v[112:115]
    v_mfma_f32_16x16x32_bf16 v[116:119], v[188:191], a[148:151], v[116:119]
    v_mfma_f32_16x16x32_bf16 v[120:123], v[188:191], a[152:155], v[120:123]
    v_mfma_f32_16x16x32_bf16 v[124:127], v[188:191], a[156:159], v[124:127]
    v_mfma_f32_16x16x32_bf16 v[128:131], v[192:195], a[0:3], 0
    s_waitcnt lgkmcnt(0)
    s_add_u32 m0, s33, 4096
    v_max3_f32 v248, v88, v89, v90
    v_max3_f32 v249, v91, v108, v109
    v_mfma_f32_16x16x32_bf16 v[132:135], v[192:195], a[4:7], 0
    s_xor_b32 s34, s100, 49536
    buffer_load_dwordx4 v4, s[16:19], s34 offen offset:0 nt lds
    v_max3_f32 v248, v248, v110, v111
    v_max3_f32 v40, v40, v248, v249
    v_mfma_f32_16x16x32_bf16 v[136:139], v[192:195], a[8:11], 0
    buffer_load_dwordx4 v5, s[16:19], s34 offen offset:1024 nt lds
    buffer_load_dwordx4 v6, s[16:19], s34 offen offset:2048 nt lds
    v_max3_f32 v250, v92, v93, v94
    v_max3_f32 v251, v95, v112, v113
    v_mfma_f32_16x16x32_bf16 v[140:143], v[192:195], a[12:15], 0
    buffer_load_dwordx4 v7, s[16:19], s34 offen offset:3072 nt lds
    s_waitcnt vmcnt(16)
    v_max3_f32 v250, v250, v114, v115
    v_max3_f32 v41, v41, v250, v251
    v_mfma_f32_16x16x32_bf16 v[144:147], v[192:195], a[16:19], 0
    ds_read_b128 a[208:211], v24 offset:12288
    ds_read_b128 a[212:215], v24 offset:14336
    v_max3_f32 v248, v96, v97, v98
    v_max3_f32 v249, v99, v116, v117
    v_mfma_f32_16x16x32_bf16 v[148:151], v[196:199], a[0:3], 0
    ds_read_b128 a[216:219], v25 offset:12288
    ds_read_b128 a[220:223], v25 offset:14336
    v_max3_f32 v248, v248, v118, v119
    v_max3_f32 v42, v42, v248, v249
    v_mfma_f32_16x16x32_bf16 v[152:155], v[196:199], a[4:7], 0
    v_max3_f32 v250, v100, v101, v102
    v_max3_f32 v251, v103, v120, v121
    v_max3_f32 v250, v250, v122, v123
    v_max3_f32 v43, v43, v250, v251
    v_mfma_f32_16x16x32_bf16 v[156:159], v[196:199], a[8:11], 0
    v_max3_f32 v248, v104, v105, v106
    v_max3_f32 v249, v107, v124, v125
    v_max3_f32 v248, v248, v126, v127
    v_max3_f32 v44, v44, v248, v249
    v_mfma_f32_16x16x32_bf16 v[160:163], v[196:199], a[12:15], 0
    v_mov_b32 v248, v40
    v_mov_b32 v249, v41
    v_mov_b32 v250, v42
    v_mov_b32 v251, v43
    v_mfma_f32_16x16x32_bf16 v[164:167], v[196:199], a[16:19], 0
    v_mov_b32 v252, v44
    v_permlane32_swap_b32 v40, v248
    v_permlane32_swap_b32 v41, v249
    v_permlane32_swap_b32 v42, v250
    v_mfma_f32_16x16x32_bf16 v[128:131], v[200:203], a[20:23], v[128:131]
    v_permlane32_swap_b32 v43, v251
    v_permlane32_swap_b32 v44, v252
    v_max_f32 v40, v40, v248
    v_max_f32 v41, v41, v249
    v_mfma_f32_16x16x32_bf16 v[132:135], v[200:203], a[24:27], v[132:135]
    v_max_f32 v42, v42, v250
    v_max_f32 v43, v43, v251
    v_max_f32 v44, v44, v252
    v_mov_b32 v248, v40
    v_mfma_f32_16x16x32_bf16 v[136:139], v[200:203], a[28:31], v[136:139]
    v_mov_b32 v249, v41
    v_mov_b32 v250, v42
    v_mov_b32 v251, v43
    v_mov_b32 v252, v44
    v_mfma_f32_16x16x32_bf16 v[140:143], v[200:203], a[32:35], v[140:143]
    v_permlane16_swap_b32 v40, v248
    v_permlane16_swap_b32 v41, v249
    v_permlane16_swap_b32 v42, v250
    v_permlane16_swap_b32 v43, v251
    v_mfma_f32_16x16x32_bf16 v[144:147], v[200:203], a[36:39], v[144:147]
    v_permlane16_swap_b32 v44, v252
    v_max_f32 v40, v40, v248
    v_max_f32 v41, v41, v249
    v_max_f32 v42, v42, v250
    v_mfma_f32_16x16x32_bf16 v[148:151], v[204:207], a[20:23], v[148:151]
    v_max_f32 v43, v43, v251
    v_max_f32 v44, v44, v252
    v_mfma_f32_16x16x32_bf16 v[152:155], v[204:207], a[24:27], v[152:155]
    v_mfma_f32_16x16x32_bf16 v[156:159], v[204:207], a[28:31], v[156:159]
    v_mfma_f32_16x16x32_bf16 v[160:163], v[204:207], a[32:35], v[160:163]
    v_mfma_f32_16x16x32_bf16 v[164:167], v[204:207], a[36:39], v[164:167]
    ds_write_b32 v32, v40 offset:8192
    ds_write_b32 v32, v41 offset:8448
    ds_write_b32 v32, v42 offset:8704
    ds_write_b32 v32, v43 offset:8960
    ds_write_b32 v32, v44 offset:9216
    v_mfma_f32_16x16x32_bf16 v[128:131], a[232:235], a[40:43], v[128:131]
    s_waitcnt lgkmcnt(0)
    s_barrier
    ds_read_b128 v[208:211], v33 offset:8192
    v_mfma_f32_16x16x32_bf16 v[132:135], a[232:235], a[44:47], v[132:135]
    ds_read_b128 v[212:215], v33 offset:8448
    ds_read_b128 v[216:219], v33 offset:8704
    v_mfma_f32_16x16x32_bf16 v[136:139], a[232:235], a[48:51], v[136:139]
    ds_read_b128 v[220:223], v33 offset:8960
    ds_read_b128 v[224:227], v33 offset:9216
    s_waitcnt lgkmcnt(4)
    v_max3_f32 v40, v208, v209, v210
    s_waitcnt lgkmcnt(3)
    v_max3_f32 v41, v212, v213, v214
    v_mfma_f32_16x16x32_bf16 v[140:143], a[232:235], a[52:55], v[140:143]
    s_add_u32 m0, s33, 12288
    s_waitcnt lgkmcnt(2)
    v_max3_f32 v42, v216, v217, v218
    s_waitcnt lgkmcnt(1)
    v_max3_f32 v43, v220, v221, v222
    v_mfma_f32_16x16x32_bf16 v[144:147], a[232:235], a[56:59], v[144:147]
    s_xor_b32 s34, s101, 0
    buffer_load_dwordx4 v4, s[20:23], s34 offen offset:0 nt lds
    s_waitcnt lgkmcnt(0)
    v_max3_f32 v44, v224, v225, v226
    v_max_f32 v40, v40, v211
    v_mfma_f32_16x16x32_bf16 v[148:151], a[236:239], a[40:43], v[148:151]
    buffer_load_dwordx4 v5, s[20:23], s34 offen offset:1024 nt lds
    buffer_load_dwordx4 v6, s[20:23], s34 offen offset:2048 nt lds
    v_max_f32 v41, v41, v215
    v_max_f32 v42, v42, v219
    v_mfma_f32_16x16x32_bf16 v[152:155], a[236:239], a[44:47], v[152:155]
    buffer_load_dwordx4 v7, s[20:23], s34 offen offset:3072 nt lds
    s_waitcnt vmcnt(16)
    v_max_f32 v43, v43, v223
    v_max_f32 v44, v44, v227
    v_mfma_f32_16x16x32_bf16 v[156:159], a[236:239], a[48:51], v[156:159]
    ds_read_b128 a[160:163], v24 offset:8192
    ds_read_b128 a[164:167], v24 offset:10240
    v_mul_f32 v40, s37, v40
    v_mul_f32 v41, s37, v41
    v_mfma_f32_16x16x32_bf16 v[160:163], a[236:239], a[52:55], v[160:163]
    ds_read_b128 a[168:171], v25 offset:8192
    ds_read_b128 a[172:175], v25 offset:10240
    v_mul_f32 v42, s37, v42
    v_mul_f32 v43, s37, v43
    v_mfma_f32_16x16x32_bf16 v[164:167], a[236:239], a[56:59], v[164:167]
    v_mul_f32 v44, s37, v44
    v_fma_f32 v48, v48, s37, -v40
    v_fma_f32 v49, v49, s37, -v40
    v_fma_f32 v50, v50, s37, -v40
    v_mfma_f32_16x16x32_bf16 v[128:131], a[240:243], a[60:63], v[128:131]
    v_fma_f32 v51, v51, s37, -v40
    v_fma_f32 v68, v68, s37, -v40
    v_fma_f32 v69, v69, s37, -v40
    v_fma_f32 v70, v70, s37, -v40
    v_mfma_f32_16x16x32_bf16 v[132:135], a[240:243], a[64:67], v[132:135]
    v_fma_f32 v71, v71, s37, -v40
    v_exp_f32 v48, v48
    v_exp_f32 v49, v49
    v_exp_f32 v50, v50
    v_mfma_f32_16x16x32_bf16 v[136:139], a[240:243], a[68:71], v[136:139]
    v_exp_f32 v51, v51
    v_exp_f32 v68, v68
    v_exp_f32 v69, v69
    v_exp_f32 v70, v70
    v_mfma_f32_16x16x32_bf16 v[140:143], a[240:243], a[72:75], v[140:143]
    v_exp_f32 v71, v71
    v_cvt_pk_bf16_f32 v48, v48, v49
    v_cvt_pk_bf16_f32 v49, v50, v51
    v_cvt_pk_bf16_f32 v50, v68, v69
    v_mfma_f32_16x16x32_bf16 v[144:147], a[240:243], a[76:79], v[144:147]
    v_cvt_pk_bf16_f32 v51, v70, v71
    v_fma_f32 v52, v52, s37, -v41
    v_mfma_f32_16x16x32_bf16 v[148:151], a[244:247], a[60:63], v[148:151]
    v_mfma_f32_16x16x32_bf16 v[152:155], a[244:247], a[64:67], v[152:155]
    v_mfma_f32_16x16x32_bf16 v[156:159], a[244:247], a[68:71], v[156:159]
    v_mfma_f32_16x16x32_bf16 v[160:163], a[244:247], a[72:75], v[160:163]
    v_mfma_f32_16x16x32_bf16 v[164:167], a[244:247], a[76:79], v[164:167]
    v_mfma_f32_16x16x32_bf16 v[128:131], a[192:195], a[80:83], v[128:131]
    s_waitcnt lgkmcnt(0)
    s_add_u32 m0, s33, 8192
    v_fma_f32 v53, v53, s37, -v41
    v_fma_f32 v54, v54, s37, -v41
    v_mfma_f32_16x16x32_bf16 v[132:135], a[192:195], a[84:87], v[132:135]
    s_xor_b32 s34, s101, 16384
    buffer_load_dwordx4 v4, s[20:23], s34 offen offset:0 nt lds
    v_fma_f32 v55, v55, s37, -v41
    v_fma_f32 v72, v72, s37, -v41
    v_mfma_f32_16x16x32_bf16 v[136:139], a[192:195], a[88:91], v[136:139]
    buffer_load_dwordx4 v5, s[20:23], s34 offen offset:1024 nt lds
    buffer_load_dwordx4 v6, s[20:23], s34 offen offset:2048 nt lds
    v_fma_f32 v73, v73, s37, -v41
    v_fma_f32 v74, v74, s37, -v41
    v_mfma_f32_16x16x32_bf16 v[140:143], a[192:195], a[92:95], v[140:143]
    buffer_load_dwordx4 v7, s[20:23], s34 offen offset:3072 nt lds
    s_waitcnt vmcnt(16)
    v_fma_f32 v75, v75, s37, -v41
    v_exp_f32 v52, v52
    v_mfma_f32_16x16x32_bf16 v[144:147], a[192:195], a[96:99], v[144:147]
    ds_read_b128 a[176:179], v24 offset:0
    ds_read_b128 a[180:183], v24 offset:2048
    v_exp_f32 v53, v53
    v_exp_f32 v54, v54
    v_mfma_f32_16x16x32_bf16 v[148:151], a[196:199], a[80:83], v[148:151]
    ds_read_b128 a[184:187], v25 offset:0
    ds_read_b128 a[188:191], v25 offset:2048
    v_exp_f32 v55, v55
    v_exp_f32 v72, v72
    v_mfma_f32_16x16x32_bf16 v[152:155], a[196:199], a[84:87], v[152:155]
    v_exp_f32 v73, v73
    v_exp_f32 v74, v74
    v_exp_f32 v75, v75
    v_mfma_f32_16x16x32_bf16 v[228:231], a[252:255], v[48:51], 0
    v_mfma_f32_16x16x32_bf16 v[156:159], a[196:199], a[88:91], v[156:159]
    v_cvt_pk_bf16_f32 v52, v52, v53
    v_cvt_pk_bf16_f32 v53, v54, v55
    v_cvt_pk_bf16_f32 v54, v72, v73
    v_cvt_pk_bf16_f32 v55, v74, v75
    v_mfma_f32_16x16x32_bf16 v[160:163], a[196:199], a[92:95], v[160:163]
    v_fma_f32 v56, v56, s37, -v42
    v_fma_f32 v57, v57, s37, -v42
    v_fma_f32 v58, v58, s37, -v42
    v_fma_f32 v59, v59, s37, -v42
    v_mfma_f32_16x16x32_bf16 v[164:167], a[196:199], a[96:99], v[164:167]
    v_fma_f32 v76, v76, s37, -v42
    v_fma_f32 v77, v77, s37, -v42
    v_fma_f32 v78, v78, s37, -v42
    v_fma_f32 v79, v79, s37, -v42
    v_mfma_f32_16x16x32_bf16 v[128:131], a[200:203], a[100:103], v[128:131]
    v_exp_f32 v56, v56
    v_exp_f32 v57, v57
    v_exp_f32 v58, v58
    v_exp_f32 v59, v59
    v_mfma_f32_16x16x32_bf16 v[132:135], a[200:203], a[104:107], v[132:135]
    v_exp_f32 v76, v76
    v_exp_f32 v77, v77
    v_exp_f32 v78, v78
    v_exp_f32 v79, v79
    v_mfma_f32_16x16x32_bf16 v[136:139], a[200:203], a[108:111], v[136:139]
    ds_write_b128 v31, v[48:51] offset:0
    v_mfma_f32_16x16x32_bf16 v[232:235], a[252:255], v[52:55], 0
    v_cvt_pk_bf16_f32 v56, v56, v57
    v_cvt_pk_bf16_f32 v57, v58, v59
    v_mfma_f32_16x16x32_bf16 v[140:143], a[200:203], a[112:115], v[140:143]
    v_cvt_pk_bf16_f32 v58, v76, v77
    v_cvt_pk_bf16_f32 v59, v78, v79
    v_fma_f32 v60, v60, s37, -v43
    v_fma_f32 v61, v61, s37, -v43
    v_mfma_f32_16x16x32_bf16 v[144:147], a[200:203], a[116:119], v[144:147]
    v_fma_f32 v62, v62, s37, -v43
    v_fma_f32 v63, v63, s37, -v43
    v_fma_f32 v80, v80, s37, -v43
    v_fma_f32 v81, v81, s37, -v43
    v_mfma_f32_16x16x32_bf16 v[148:151], a[204:207], a[100:103], v[148:151]
    v_fma_f32 v82, v82, s37, -v43
    v_mfma_f32_16x16x32_bf16 v[152:155], a[204:207], a[104:107], v[152:155]
    v_mfma_f32_16x16x32_bf16 v[156:159], a[204:207], a[108:111], v[156:159]
    v_mfma_f32_16x16x32_bf16 v[160:163], a[204:207], a[112:115], v[160:163]
    v_mfma_f32_16x16x32_bf16 v[164:167], a[204:207], a[116:119], v[164:167]
    v_mfma_f32_16x16x32_bf16 v[128:131], a[208:211], a[120:123], v[128:131]
    s_waitcnt lgkmcnt(1)
    s_add_u32 m0, s33, 0
    v_fma_f32 v83, v83, s37, -v43
    v_exp_f32 v60, v60
    v_mfma_f32_16x16x32_bf16 v[132:135], a[208:211], a[124:127], v[132:135]
    s_xor_b32 s34, s101, 65536
    buffer_load_dwordx4 v4, s[20:23], s34 offen offset:0 nt lds
    v_exp_f32 v61, v61
    v_exp_f32 v62, v62
    v_mfma_f32_16x16x32_bf16 v[136:139], a[208:211], a[128:131], v[136:139]
    buffer_load_dwordx4 v5, s[20:23], s34 offen offset:1024 nt lds
    buffer_load_dwordx4 v6, s[20:23], s34 offen offset:2048 nt lds
    v_exp_f32 v63, v63
    v_exp_f32 v80, v80
    v_mfma_f32_16x16x32_bf16 v[140:143], a[208:211], a[132:135], v[140:143]
    buffer_load_dwordx4 v7, s[20:23], s34 offen offset:3072 nt lds
    s_waitcnt vmcnt(16)
    v_exp_f32 v81, v81
    v_exp_f32 v82, v82
    v_mfma_f32_16x16x32_bf16 v[144:147], a[208:211], a[136:139], v[144:147]
    ds_read_b128 a[232:235], v24 offset:16384
    ds_read_b128 a[236:239], v24 offset:18432
    v_exp_f32 v83, v83
    v_mfma_f32_16x16x32_bf16 v[236:239], a[252:255], v[56:59], 0
    v_mfma_f32_16x16x32_bf16 v[148:151], a[212:215], a[120:123], v[148:151]
    ds_read_b128 a[240:243], v25 offset:16384
    ds_read_b128 a[244:247], v25 offset:18432
    v_cvt_pk_bf16_f32 v60, v60, v61
    v_cvt_pk_bf16_f32 v61, v62, v63
    v_mfma_f32_16x16x32_bf16 v[152:155], a[212:215], a[124:127], v[152:155]
    v_cvt_pk_bf16_f32 v62, v80, v81
    v_cvt_pk_bf16_f32 v63, v82, v83
    v_fma_f32 v64, v64, s37, -v44
    v_fma_f32 v65, v65, s37, -v44
    v_mfma_f32_16x16x32_bf16 v[156:159], a[212:215], a[128:131], v[156:159]
    v_fma_f32 v66, v66, s37, -v44
    v_fma_f32 v67, v67, s37, -v44
    v_fma_f32 v84, v84, s37, -v44
    v_fma_f32 v85, v85, s37, -v44
    v_mfma_f32_16x16x32_bf16 v[160:163], a[212:215], a[132:135], v[160:163]
    v_fma_f32 v86, v86, s37, -v44
    v_fma_f32 v87, v87, s37, -v44
    v_exp_f32 v64, v64
    v_exp_f32 v65, v65
    v_mfma_f32_16x16x32_bf16 v[164:167], a[212:215], a[136:139], v[164:167]
    v_exp_f32 v66, v66
    v_exp_f32 v67, v67
    v_exp_f32 v84, v84
    v_exp_f32 v85, v85
    v_mfma_f32_16x16x32_bf16 v[128:131], a[216:219], a[140:143], v[128:131]
    v_exp_f32 v86, v86
    v_exp_f32 v87, v87
    v_mfma_f32_16x16x32_bf16 v[240:243], a[252:255], v[60:63], 0
    v_cvt_pk_bf16_f32 v64, v64, v65
    v_mfma_f32_16x16x32_bf16 v[132:135], a[216:219], a[144:147], v[132:135]
    v_cvt_pk_bf16_f32 v65, v66, v67
    v_cvt_pk_bf16_f32 v66, v84, v85
    v_cvt_pk_bf16_f32 v67, v86, v87
    v_mfma_f32_16x16x32_bf16 v[136:139], a[216:219], a[148:151], v[136:139]
    ds_write_b128 v31, v[52:55] offset:1024
    v_mfma_f32_16x16x32_bf16 v[244:247], a[252:255], v[64:67], 0
    v_fma_f32 v88, v88, s37, -v40
    v_fma_f32 v89, v89, s37, -v40
    v_mfma_f32_16x16x32_bf16 v[140:143], a[216:219], a[152:155], v[140:143]
    v_fma_f32 v90, v90, s37, -v40
    v_fma_f32 v91, v91, s37, -v40
    v_fma_f32 v108, v108, s37, -v40
    v_fma_f32 v109, v109, s37, -v40
    v_mfma_f32_16x16x32_bf16 v[144:147], a[216:219], a[156:159], v[144:147]
    ds_write_b128 v31, v[56:59] offset:2048
    v_fma_f32 v110, v110, s37, -v40
    v_fma_f32 v111, v111, s37, -v40
    v_exp_f32 v88, v88
    v_mfma_f32_16x16x32_bf16 v[148:151], a[220:223], a[140:143], v[148:151]
    v_exp_f32 v89, v89
    v_exp_f32 v90, v90
    v_mfma_f32_16x16x32_bf16 v[152:155], a[220:223], a[144:147], v[152:155]
    v_mfma_f32_16x16x32_bf16 v[156:159], a[220:223], a[148:151], v[156:159]
    v_mfma_f32_16x16x32_bf16 v[160:163], a[220:223], a[152:155], v[160:163]
    v_mfma_f32_16x16x32_bf16 v[164:167], a[220:223], a[156:159], v[164:167]
    v_mfma_f32_16x16x32_bf16 v[168:171], a[160:163], a[0:3], 0
    s_waitcnt lgkmcnt(2)
    s_add_u32 m0, s33, 16384
    v_exp_f32 v91, v91
    v_exp_f32 v108, v108
    v_mfma_f32_16x16x32_bf16 v[172:175], a[160:163], a[4:7], 0
    s_xor_b32 s34, s101, 81920
    buffer_load_dwordx4 v4, s[20:23], s34 offen offset:0 nt lds
    v_exp_f32 v109, v109
    v_exp_f32 v110, v110
    v_mfma_f32_16x16x32_bf16 v[176:179], a[160:163], a[8:11], 0
    buffer_load_dwordx4 v5, s[20:23], s34 offen offset:1024 nt lds
    buffer_load_dwordx4 v6, s[20:23], s34 offen offset:2048 nt lds
    v_exp_f32 v111, v111
    v_cvt_pk_bf16_f32 v88, v88, v89
    v_mfma_f32_16x16x32_bf16 v[180:183], a[160:163], a[12:15], 0
    buffer_load_dwordx4 v7, s[20:23], s34 offen offset:3072 nt lds
    buffer_load_dword v253, v3, s[24:27], s97 offen
    v_cvt_pk_bf16_f32 v89, v90, v91
    v_cvt_pk_bf16_f32 v90, v108, v109
    v_mfma_f32_16x16x32_bf16 v[184:187], a[160:163], a[16:19], 0
    s_waitcnt vmcnt(17)
    ds_read_b128 a[212:215], v24 offset:4096
    v_cvt_pk_bf16_f32 v91, v110, v111
    v_fma_f32 v92, v92, s37, -v41
    v_mfma_f32_16x16x32_bf16 v[188:191], a[164:167], a[0:3], 0
    ds_read_b128 a[216:219], v24 offset:6144
    ds_read_b128 a[220:223], v25 offset:4096
    v_fma_f32 v93, v93, s37, -v41
    v_fma_f32 v94, v94, s37, -v41
    v_mfma_f32_16x16x32_bf16 v[192:195], a[164:167], a[4:7], 0
    ds_read_b128 a[224:227], v25 offset:6144
    v_fma_f32 v95, v95, s37, -v41
    v_fma_f32 v112, v112, s37, -v41
    v_fma_f32 v113, v113, s37, -v41
    v_mfma_f32_16x16x32_bf16 v[196:199], a[164:167], a[8:11], 0
    v_fma_f32 v114, v114, s37, -v41
    v_fma_f32 v115, v115, s37, -v41
    v_exp_f32 v92, v92
    v_exp_f32 v93, v93
    v_mfma_f32_16x16x32_bf16 v[200:203], a[164:167], a[12:15], 0
    v_exp_f32 v94, v94
    v_exp_f32 v95, v95
    v_exp_f32 v112, v112
    v_exp_f32 v113, v113
    v_mfma_f32_16x16x32_bf16 v[204:207], a[164:167], a[16:19], 0
    v_exp_f32 v114, v114
    v_exp_f32 v115, v115
    v_mfma_f32_16x16x32_bf16 v[228:231], a[252:255], v[88:91], v[228:231]
    v_cvt_pk_bf16_f32 v92, v92, v93
    v_mfma_f32_16x16x32_bf16 v[168:171], a[168:171], a[20:23], v[168:171]
    v_cvt_pk_bf16_f32 v93, v94, v95
    v_cvt_pk_bf16_f32 v94, v112, v113
    v_cvt_pk_bf16_f32 v95, v114, v115
    v_fma_f32 v96, v96, s37, -v42
    v_mfma_f32_16x16x32_bf16 v[172:175], a[168:171], a[24:27], v[172:175]
    v_fma_f32 v97, v97, s37, -v42
    v_fma_f32 v98, v98, s37, -v42
    v_fma_f32 v99, v99, s37, -v42
    v_fma_f32 v116, v116, s37, -v42
    v_mfma_f32_16x16x32_bf16 v[176:179], a[168:171], a[28:31], v[176:179]
    ds_write_b128 v31, v[60:63] offset:3072
    v_fma_f32 v117, v117, s37, -v42
    v_fma_f32 v118, v118, s37, -v42
    v_fma_f32 v119, v119, s37, -v42
    v_mfma_f32_16x16x32_bf16 v[180:183], a[168:171], a[32:35], v[180:183]
    v_exp_f32 v96, v96
    v_exp_f32 v97, v97
    v_exp_f32 v98, v98
    v_exp_f32 v99, v99
    v_mfma_f32_16x16x32_bf16 v[184:187], a[168:171], a[36:39], v[184:187]
    ds_write_b128 v31, v[64:67] offset:4096
    v_exp_f32 v116, v116
    v_exp_f32 v117, v117
    v_exp_f32 v118, v118
    v_mfma_f32_16x16x32_bf16 v[188:191], a[172:175], a[20:23], v[188:191]
    v_exp_f32 v119, v119
    v_mfma_f32_16x16x32_bf16 v[232:235], a[252:255], v[92:95], v[232:235]
    v_cvt_pk_bf16_f32 v96, v96, v97
    v_mfma_f32_16x16x32_bf16 v[192:195], a[172:175], a[24:27], v[192:195]
    v_mfma_f32_16x16x32_bf16 v[196:199], a[172:175], a[28:31], v[196:199]
    v_mfma_f32_16x16x32_bf16 v[200:203], a[172:175], a[32:35], v[200:203]
    v_mfma_f32_16x16x32_bf16 v[204:207], a[172:175], a[36:39], v[204:207]
    v_mfma_f32_16x16x32_bf16 v[168:171], a[176:179], a[40:43], v[168:171]
    s_waitcnt lgkmcnt(2)
    s_add_u32 m0, s33, 4096
    v_cvt_pk_bf16_f32 v97, v98, v99
    v_mfma_f32_16x16x32_bf16 v[172:175], a[176:179], a[44:47], v[172:175]
    s_xor_b32 s34, s101, 131072
    buffer_load_dwordx4 v4, s[20:23], s34 offen offset:0 nt lds
    v_cvt_pk_bf16_f32 v98, v116, v117
    v_mfma_f32_16x16x32_bf16 v[176:179], a[176:179], a[48:51], v[176:179]
    buffer_load_dwordx4 v5, s[20:23], s34 offen offset:1024 nt lds
    buffer_load_dwordx4 v6, s[20:23], s34 offen offset:2048 nt lds
    v_cvt_pk_bf16_f32 v99, v118, v119
    v_mfma_f32_16x16x32_bf16 v[180:183], a[176:179], a[52:55], v[180:183]
    buffer_load_dwordx4 v7, s[20:23], s34 offen offset:3072 nt lds
    v_fma_f32 v100, v100, s37, -v43
    v_fma_f32 v101, v101, s37, -v43
    v_mfma_f32_16x16x32_bf16 v[184:187], a[176:179], a[56:59], v[184:187]
    v_fma_f32 v102, v102, s37, -v43
    v_fma_f32 v103, v103, s37, -v43
    v_fma_f32 v120, v120, s37, -v43
    v_mfma_f32_16x16x32_bf16 v[188:191], a[180:183], a[40:43], v[188:191]
    v_fma_f32 v121, v121, s37, -v43
    v_fma_f32 v122, v122, s37, -v43
    v_fma_f32 v123, v123, s37, -v43
    v_mfma_f32_16x16x32_bf16 v[192:195], a[180:183], a[44:47], v[192:195]
    v_exp_f32 v100, v100
    v_exp_f32 v101, v101
    v_exp_f32 v102, v102
    v_mfma_f32_16x16x32_bf16 v[196:199], a[180:183], a[48:51], v[196:199]
    v_exp_f32 v103, v103
    v_exp_f32 v120, v120
    v_exp_f32 v121, v121
    v_mfma_f32_16x16x32_bf16 v[200:203], a[180:183], a[52:55], v[200:203]
    v_exp_f32 v122, v122
    v_exp_f32 v123, v123
    v_mfma_f32_16x16x32_bf16 v[236:239], a[252:255], v[96:99], v[236:239]
    v_mfma_f32_16x16x32_bf16 v[204:207], a[180:183], a[56:59], v[204:207]
    v_cvt_pk_bf16_f32 v100, v100, v101
    v_cvt_pk_bf16_f32 v101, v102, v103
    v_cvt_pk_bf16_f32 v102, v120, v121
    v_mfma_f32_16x16x32_bf16 v[168:171], a[184:187], a[60:63], v[168:171]
    v_cvt_pk_bf16_f32 v103, v122, v123
    v_fma_f32 v104, v104, s37, -v44
    v_fma_f32 v105, v105, s37, -v44
    v_mfma_f32_16x16x32_bf16 v[172:175], a[184:187], a[64:67], v[172:175]
    v_fma_f32 v106, v106, s37, -v44
    v_fma_f32 v107, v107, s37, -v44
    v_fma_f32 v124, v124, s37, -v44
    v_mfma_f32_16x16x32_bf16 v[176:179], a[184:187], a[68:71], v[176:179]
    ds_write_b128 v31, v[88:91] offset:5120
    v_fma_f32 v125, v125, s37, -v44
    v_fma_f32 v126, v126, s37, -v44
    v_mfma_f32_16x16x32_bf16 v[180:183], a[184:187], a[72:75], v[180:183]
    v_fma_f32 v127, v127, s37, -v44
    v_exp_f32 v104, v104
    v_exp_f32 v105, v105
    v_mfma_f32_16x16x32_bf16 v[184:187], a[184:187], a[76:79], v[184:187]
    ds_write_b128 v31, v[92:95] offset:6144
    v_exp_f32 v106, v106
    v_exp_f32 v107, v107
    v_mfma_f32_16x16x32_bf16 v[188:191], a[188:191], a[60:63], v[188:191]
    v_exp_f32 v124, v124
    v_exp_f32 v125, v125
    v_exp_f32 v126, v126
    v_mfma_f32_16x16x32_bf16 v[192:195], a[188:191], a[64:67], v[192:195]
    v_exp_f32 v127, v127
    v_mfma_f32_16x16x32_bf16 v[240:243], a[252:255], v[100:103], v[240:243]
    v_cvt_pk_bf16_f32 v104, v104, v105
    v_mfma_f32_16x16x32_bf16 v[196:199], a[188:191], a[68:71], v[196:199]
    v_cvt_pk_bf16_f32 v105, v106, v107
    v_cvt_pk_bf16_f32 v106, v124, v125
    v_cvt_pk_bf16_f32 v107, v126, v127
    v_mfma_f32_16x16x32_bf16 v[200:203], a[188:191], a[72:75], v[200:203]
    s_nop 0
    v_mfma_f32_16x16x32_bf16 v[244:247], a[252:255], v[104:107], v[244:247]
    v_mfma_f32_16x16x32_bf16 v[204:207], a[188:191], a[76:79], v[204:207]
    v_mfma_f32_16x16x32_bf16 v[168:171], a[232:235], a[80:83], v[168:171]
    s_waitcnt vmcnt(17)
    ds_read_b64_tr_b16 a[0:1], v20 offset:12288
    v_mfma_f32_16x16x32_bf16 v[172:175], a[232:235], a[84:87], v[172:175]
    ds_read_b64_tr_b16 a[2:3], v20 offset:14336
    ds_read_b64_tr_b16 a[4:5], v21 offset:12288
    v_mfma_f32_16x16x32_bf16 v[176:179], a[232:235], a[88:91], v[176:179]
    ds_read_b64_tr_b16 a[6:7], v21 offset:14336
    ds_read_b64_tr_b16 a[8:9], v22 offset:12288
    v_mfma_f32_16x16x32_bf16 v[180:183], a[232:235], a[92:95], v[180:183]
    ds_read_b64_tr_b16 a[10:11], v22 offset:14336
    ds_read_b64_tr_b16 a[12:13], v23 offset:12288
    v_mfma_f32_16x16x32_bf16 v[184:187], a[232:235], a[96:99], v[184:187]
    ds_read_b64_tr_b16 a[14:15], v23 offset:14336
    v_max3_f32 v248, v128, v129, v130
    v_mfma_f32_16x16x32_bf16 v[188:191], a[236:239], a[80:83], v[188:191]
    v_max3_f32 v249, v131, v148, v149
    v_max3_f32 v248, v248, v150, v151
    v_mfma_f32_16x16x32_bf16 v[192:195], a[236:239], a[84:87], v[192:195]
    v_max_f32 v35, v248, v249
    v_max3_f32 v250, v132, v133, v134
    v_mfma_f32_16x16x32_bf16 v[196:199], a[236:239], a[88:91], v[196:199]
    v_max3_f32 v251, v135, v152, v153
    v_max3_f32 v250, v250, v154, v155
    v_mfma_f32_16x16x32_bf16 v[200:203], a[236:239], a[92:95], v[200:203]
    v_max_f32 v36, v250, v251
    v_max3_f32 v248, v136, v137, v138
    v_mfma_f32_16x16x32_bf16 v[204:207], a[236:239], a[96:99], v[204:207]
    v_max3_f32 v249, v139, v156, v157
    v_max3_f32 v248, v248, v158, v159
    v_mfma_f32_16x16x32_bf16 v[168:171], a[240:243], a[100:103], v[168:171]
    v_max_f32 v37, v248, v249
    v_max3_f32 v250, v140, v141, v142
    v_mfma_f32_16x16x32_bf16 v[172:175], a[240:243], a[104:107], v[172:175]
    v_max3_f32 v251, v143, v160, v161
    v_max3_f32 v250, v250, v162, v163
    v_mfma_f32_16x16x32_bf16 v[176:179], a[240:243], a[108:111], v[176:179]
    ds_write_b128 v31, v[96:99] offset:7168
    v_max_f32 v38, v250, v251
    v_mfma_f32_16x16x32_bf16 v[180:183], a[240:243], a[112:115], v[180:183]
    v_max3_f32 v248, v144, v145, v146
    v_max3_f32 v249, v147, v164, v165
    v_mfma_f32_16x16x32_bf16 v[184:187], a[240:243], a[116:119], v[184:187]
    ds_write_b128 v31, v[100:103] offset:8192
    v_max3_f32 v248, v248, v166, v167
    v_mfma_f32_16x16x32_bf16 v[188:191], a[244:247], a[100:103], v[188:191]
    v_max_f32 v39, v248, v249
    s_lshr_b32 s38, s101, 17
    v_mfma_f32_16x16x32_bf16 v[192:195], a[244:247], a[104:107], v[192:195]
    ds_write_b128 v31, v[104:107] offset:9216
    s_mul_i32 s38, s38, 40960
    v_mfma_f32_16x16x32_bf16 v[196:199], a[244:247], a[108:111], v[196:199]
    v_add_u32 v34, s38, v1
    v_subrev_u32 v3, s38, v2
    v_mfma_f32_16x16x32_bf16 v[200:203], a[244:247], a[112:115], v[200:203]
    v_mfma_f32_16x16x32_bf16 v[204:207], a[244:247], a[116:119], v[204:207]
    v_mfma_f32_16x16x32_bf16 v[168:171], a[212:215], a[120:123], v[168:171]
    s_waitcnt lgkmcnt(0)
    s_barrier
    v_mfma_f32_16x16x32_bf16 v[172:175], a[212:215], a[124:127], v[172:175]
    s_add_u32 m0, s33, 12288
    s_xor_b32 s34, s101, 147456
    v_mfma_f32_16x16x32_bf16 v[176:179], a[212:215], a[128:131], v[176:179]
    buffer_load_dwordx4 v4, s[20:23], s34 offen offset:0 nt lds
    buffer_load_dwordx4 v5, s[20:23], s34 offen offset:1024 nt lds
    v_mfma_f32_16x16x32_bf16 v[180:183], a[212:215], a[132:135], v[180:183]
    buffer_load_dwordx4 v6, s[20:23], s34 offen offset:2048 nt lds
    buffer_load_dwordx4 v7, s[20:23], s34 offen offset:3072 nt lds
    v_mfma_f32_16x16x32_bf16 v[184:187], a[212:215], a[136:139], v[184:187]
    ds_read_b128 a[192:195], v34 offset:0
    ds_read_b128 a[196:199], v34 offset:1024
    v_mfma_f32_16x16x32_bf16 v[188:191], a[216:219], a[120:123], v[188:191]
    ds_read_b128 a[200:203], v34 offset:2048
    ds_read_b128 a[204:207], v34 offset:3072
    v_mfma_f32_16x16x32_bf16 v[192:195], a[216:219], a[124:127], v[192:195]
    ds_read_b128 a[208:211], v34 offset:4096
    s_waitcnt vmcnt(17)
    v_mfma_f32_16x16x32_bf16 v[196:199], a[216:219], a[128:131], v[196:199]
    ds_read_b64_tr_b16 a[16:17], v20 offset:8192
    ds_read_b64_tr_b16 a[18:19], v20 offset:10240
    v_mfma_f32_16x16x32_bf16 v[200:203], a[216:219], a[132:135], v[200:203]
    ds_read_b64_tr_b16 a[20:21], v21 offset:8192
    ds_read_b64_tr_b16 a[22:23], v21 offset:10240
    v_mfma_f32_16x16x32_bf16 v[204:207], a[216:219], a[136:139], v[204:207]
    ds_read_b64_tr_b16 a[24:25], v22 offset:8192
    ds_read_b64_tr_b16 a[26:27], v22 offset:10240
    v_mfma_f32_16x16x32_bf16 v[168:171], a[220:223], a[140:143], v[168:171]
    ds_read_b64_tr_b16 a[28:29], v23 offset:8192
    ds_read_b64_tr_b16 a[30:31], v23 offset:10240
    v_mfma_f32_16x16x32_bf16 v[172:175], a[220:223], a[144:147], v[172:175]
    v_mov_b32 v47, 0
    buffer_load_dwordx2 v[254:255], v47, s[80:83], 0 offen sc0 sc1
    v_mfma_f32_16x16x32_bf16 v[176:179], a[220:223], a[148:151], v[176:179]
    v_mfma_f32_16x16x32_bf16 v[180:183], a[220:223], a[152:155], v[180:183]
    v_mfma_f32_16x16x32_bf16 v[184:187], a[220:223], a[156:159], v[184:187]
    v_mfma_f32_16x16x32_bf16 v[188:191], a[224:227], a[140:143], v[188:191]
    v_mfma_f32_16x16x32_bf16 v[192:195], a[224:227], a[144:147], v[192:195]
    v_mfma_f32_16x16x32_bf16 v[196:199], a[224:227], a[148:151], v[196:199]
    v_mfma_f32_16x16x32_bf16 v[200:203], a[224:227], a[152:155], v[200:203]
    v_mfma_f32_16x16x32_bf16 v[204:207], a[224:227], a[156:159], v[204:207]
    s_waitcnt lgkmcnt(8)
    v_mfma_f32_16x16x32_bf16 v[48:51], a[0:3], a[192:195], 0
    s_waitcnt lgkmcnt(0)
    s_add_u32 m0, s33, 8192
    v_mfma_f32_16x16x32_bf16 v[52:55], a[0:3], a[196:199], 0
    s_xor_b32 s34, s101, 196608
    buffer_load_dwordx4 v4, s[20:23], s34 offen offset:0 nt lds
    v_max3_f32 v248, v168, v169, v170
    v_mfma_f32_16x16x32_bf16 v[56:59], a[0:3], a[200:203], 0
    buffer_load_dwordx4 v5, s[20:23], s34 offen offset:1024 nt lds
    buffer_load_dwordx4 v6, s[20:23], s34 offen offset:2048 nt lds
    v_max3_f32 v249, v171, v188, v189
    v_max3_f32 v248, v248, v190, v191
    v_mfma_f32_16x16x32_bf16 v[60:63], a[0:3], a[204:207], 0
    buffer_load_dwordx4 v7, s[20:23], s34 offen offset:3072 nt lds
    ds_read_b128 a[212:215], v34 offset:5120
    v_max3_f32 v35, v35, v248, v249
    v_max3_f32 v250, v172, v173, v174
    v_mfma_f32_16x16x32_bf16 v[64:67], a[0:3], a[208:211], 0
    ds_read_b128 a[216:219], v34 offset:6144
    ds_read_b128 a[220:223], v34 offset:7168
    v_max3_f32 v251, v175, v192, v193
    v_max3_f32 v250, v250, v194, v195
    v_mfma_f32_16x16x32_bf16 v[68:71], a[4:7], a[192:195], 0
    ds_read_b128 a[224:227], v34 offset:8192
    ds_read_b128 a[228:231], v34 offset:9216
    v_max3_f32 v36, v36, v250, v251
    v_max3_f32 v248, v176, v177, v178
    v_mfma_f32_16x16x32_bf16 v[72:75], a[4:7], a[196:199], 0
    s_waitcnt vmcnt(18)
    ds_read_b64_tr_b16 a[32:33], v20 offset:0
    v_max3_f32 v249, v179, v196, v197
    v_max3_f32 v248, v248, v198, v199
    v_mfma_f32_16x16x32_bf16 v[76:79], a[4:7], a[200:203], 0
    ds_read_b64_tr_b16 a[34:35], v20 offset:2048
    ds_read_b64_tr_b16 a[36:37], v21 offset:0
    v_max3_f32 v37, v37, v248, v249
    v_max3_f32 v250, v180, v181, v182
    v_mfma_f32_16x16x32_bf16 v[80:83], a[4:7], a[204:207], 0
    ds_read_b64_tr_b16 a[38:39], v21 offset:2048
    ds_read_b64_tr_b16 a[40:41], v22 offset:0
    v_max3_f32 v251, v183, v200, v201
    v_max3_f32 v250, v250, v202, v203
    v_mfma_f32_16x16x32_bf16 v[84:87], a[4:7], a[208:211], 0
    ds_read_b64_tr_b16 a[42:43], v22 offset:2048
    ds_read_b64_tr_b16 a[44:45], v23 offset:0
    v_max3_f32 v38, v38, v250, v251
    v_max3_f32 v248, v184, v185, v186
    v_mfma_f32_16x16x32_bf16 v[88:91], a[8:11], a[192:195], 0
    ds_read_b64_tr_b16 a[46:47], v23 offset:2048
    v_max3_f32 v249, v187, v204, v205
    v_max3_f32 v248, v248, v206, v207
    v_max3_f32 v39, v39, v248, v249
    v_mfma_f32_16x16x32_bf16 v[92:95], a[8:11], a[196:199], 0
    v_mov_b32 v248, v35
    v_mov_b32 v249, v36
    v_mov_b32 v250, v37
    v_mov_b32 v251, v38
    v_mfma_f32_16x16x32_bf16 v[96:99], a[8:11], a[200:203], 0
    v_mov_b32 v252, v39
    v_permlane32_swap_b32 v35, v248
    v_permlane32_swap_b32 v36, v249
    v_permlane32_swap_b32 v37, v250
    v_mfma_f32_16x16x32_bf16 v[100:103], a[8:11], a[204:207], 0
    v_permlane32_swap_b32 v38, v251
    v_permlane32_swap_b32 v39, v252
    v_max_f32 v35, v35, v248
    v_max_f32 v36, v36, v249
    v_mfma_f32_16x16x32_bf16 v[104:107], a[8:11], a[208:211], 0
    v_max_f32 v37, v37, v250
    v_max_f32 v38, v38, v251
    v_max_f32 v39, v39, v252
    v_mov_b32 v248, v35
    v_mfma_f32_16x16x32_bf16 v[108:111], a[12:15], a[192:195], 0
    v_mov_b32 v249, v36
    v_mov_b32 v250, v37
    v_mov_b32 v251, v38
    v_mov_b32 v252, v39
    v_mfma_f32_16x16x32_bf16 v[112:115], a[12:15], a[196:199], 0
    v_permlane16_swap_b32 v35, v248
    v_permlane16_swap_b32 v36, v249
    v_permlane16_swap_b32 v37, v250
    v_permlane16_swap_b32 v38, v251
    v_mfma_f32_16x16x32_bf16 v[116:119], a[12:15], a[200:203], 0
    v_permlane16_swap_b32 v39, v252
    v_max_f32 v35, v35, v248
    v_max_f32 v36, v36, v249
    v_max_f32 v37, v37, v250
    v_mfma_f32_16x16x32_bf16 v[120:123], a[12:15], a[204:207], 0
    v_max_f32 v38, v38, v251
    v_max_f32 v39, v39, v252
    v_mfma_f32_16x16x32_bf16 v[124:127], a[12:15], a[208:211], 0
    ds_write_b32 v32, v35 offset:18432
    ds_write_b32 v32, v36 offset:18688
    ds_write_b32 v32, v37 offset:18944
    ds_write_b32 v32, v38 offset:19200
    ds_write_b32 v32, v39 offset:19456
    s_waitcnt lgkmcnt(13)
    v_mfma_f32_16x16x32_bf16 v[48:51], a[16:19], a[212:215], v[48:51]
    s_waitcnt lgkmcnt(0)
    s_barrier
    ds_read_b128 v[208:211], v33 offset:18432
    v_mfma_f32_16x16x32_bf16 v[52:55], a[16:19], a[216:219], v[52:55]
    ds_read_b128 v[212:215], v33 offset:18688
    ds_read_b128 v[216:219], v33 offset:18944
    v_mfma_f32_16x16x32_bf16 v[56:59], a[16:19], a[220:223], v[56:59]
    ds_read_b128 v[220:223], v33 offset:19200
    ds_read_b128 v[224:227], v33 offset:19456
    s_waitcnt lgkmcnt(4)
    v_max3_f32 v35, v208, v209, v210
    s_waitcnt lgkmcnt(3)
    v_max3_f32 v36, v212, v213, v214
    v_mfma_f32_16x16x32_bf16 v[60:63], a[16:19], a[224:227], v[60:63]
    s_add_u32 m0, s33, 0
    s_waitcnt lgkmcnt(2)
    v_max3_f32 v37, v216, v217, v218
    s_waitcnt lgkmcnt(1)
    v_max3_f32 v38, v220, v221, v222
    v_mfma_f32_16x16x32_bf16 v[64:67], a[16:19], a[228:231], v[64:67]
    s_xor_b32 s34, s101, 212992
    buffer_load_dwordx4 v4, s[20:23], s34 offen offset:0 nt lds
    s_waitcnt lgkmcnt(0)
    v_max3_f32 v39, v224, v225, v226
    v_max_f32 v35, v35, v211
    v_mfma_f32_16x16x32_bf16 v[68:71], a[20:23], a[212:215], v[68:71]
    buffer_load_dwordx4 v5, s[20:23], s34 offen offset:1024 nt lds
    buffer_load_dwordx4 v6, s[20:23], s34 offen offset:2048 nt lds
    v_max_f32 v36, v36, v215
    v_max_f32 v37, v37, v219
    v_mfma_f32_16x16x32_bf16 v[72:75], a[20:23], a[216:219], v[72:75]
    buffer_load_dwordx4 v7, s[20:23], s34 offen offset:3072 nt lds
    ds_read_b128 a[192:195], v34 offset:20480
    v_max_f32 v38, v38, v223
    v_max_f32 v39, v39, v227
    v_mfma_f32_16x16x32_bf16 v[76:79], a[20:23], a[220:223], v[76:79]
    ds_read_b128 a[196:199], v34 offset:21504
    ds_read_b128 a[200:203], v34 offset:22528
    v_mul_f32 v35, s37, v35
    v_mul_f32 v36, s37, v36
    v_mfma_f32_16x16x32_bf16 v[80:83], a[20:23], a[224:227], v[80:83]
    ds_read_b128 a[204:207], v34 offset:23552
    ds_read_b128 a[208:211], v34 offset:24576
    v_mul_f32 v37, s37, v37
    v_mul_f32 v38, s37, v38
    v_mfma_f32_16x16x32_bf16 v[84:87], a[20:23], a[228:231], v[84:87]
    s_waitcnt vmcnt(18)
    ds_read_b64_tr_b16 a[48:49], v20 offset:16384
    v_mul_f32 v39, s37, v39
    v_max_f32 v35, v35, v40
    v_mfma_f32_16x16x32_bf16 v[88:91], a[24:27], a[212:215], v[88:91]
    ds_read_b64_tr_b16 a[50:51], v20 offset:18432
    ds_read_b64_tr_b16 a[52:53], v21 offset:16384
    v_max_f32 v36, v36, v41
    v_max_f32 v37, v37, v42
    v_mfma_f32_16x16x32_bf16 v[92:95], a[24:27], a[216:219], v[92:95]
    ds_read_b64_tr_b16 a[54:55], v21 offset:18432
    ds_read_b64_tr_b16 a[56:57], v22 offset:16384
    v_max_f32 v38, v38, v43
    v_max_f32 v39, v39, v44
    v_mfma_f32_16x16x32_bf16 v[96:99], a[24:27], a[220:223], v[96:99]
    ds_read_b64_tr_b16 a[58:59], v22 offset:18432
    ds_read_b64_tr_b16 a[60:61], v23 offset:16384
    v_sub_f32 v40, v40, v35
    v_sub_f32 v41, v41, v36
    v_mfma_f32_16x16x32_bf16 v[100:103], a[24:27], a[224:227], v[100:103]
    ds_read_b64_tr_b16 a[62:63], v23 offset:18432
    v_sub_f32 v42, v42, v37
    v_sub_f32 v43, v43, v38
    v_sub_f32 v44, v44, v39
    v_mfma_f32_16x16x32_bf16 v[104:107], a[24:27], a[228:231], v[104:107]
    v_exp_f32 v40, v40
    v_exp_f32 v41, v41
    v_exp_f32 v42, v42
    v_exp_f32 v43, v43
    v_mfma_f32_16x16x32_bf16 v[108:111], a[28:31], a[212:215], v[108:111]
    v_exp_f32 v44, v44
    v_mul_f32 v228, v40, v228
    v_mul_f32 v232, v41, v232
    v_mul_f32 v236, v42, v236
    v_mfma_f32_16x16x32_bf16 v[112:115], a[28:31], a[216:219], v[112:115]
    v_mul_f32 v240, v43, v240
    v_mul_f32 v244, v44, v244
    v_mfma_f32_16x16x32_bf16 v[116:119], a[28:31], a[220:223], v[116:119]
    v_mfma_f32_16x16x32_bf16 v[120:123], a[28:31], a[224:227], v[120:123]
    v_mfma_f32_16x16x32_bf16 v[124:127], a[28:31], a[228:231], v[124:127]
    s_waitcnt lgkmcnt(8)
    v_mfma_f32_16x16x32_bf16 v[48:51], a[32:35], a[192:195], v[48:51]
    s_waitcnt lgkmcnt(0)
    s_add_u32 m0, s33, 16384
    v_fma_f32 v128, v128, s37, -v35
    v_fma_f32 v129, v129, s37, -v35
    v_mfma_f32_16x16x32_bf16 v[52:55], a[32:35], a[196:199], v[52:55]
    s_xor_b32 s34, s101, 32768
    buffer_load_dwordx4 v4, s[20:23], s34 offen offset:0 nt lds
    v_fma_f32 v130, v130, s37, -v35
    v_fma_f32 v131, v131, s37, -v35
    v_mfma_f32_16x16x32_bf16 v[56:59], a[32:35], a[200:203], v[56:59]
    buffer_load_dwordx4 v5, s[20:23], s34 offen offset:1024 nt lds
    buffer_load_dwordx4 v6, s[20:23], s34 offen offset:2048 nt lds
    v_fma_f32 v148, v148, s37, -v35
    v_fma_f32 v149, v149, s37, -v35
    v_mfma_f32_16x16x32_bf16 v[60:63], a[32:35], a[204:207], v[60:63]
    buffer_load_dwordx4 v7, s[20:23], s34 offen offset:3072 nt lds
    ds_read_b128 a[212:215], v34 offset:25600
    v_fma_f32 v150, v150, s37, -v35
    v_fma_f32 v151, v151, s37, -v35
    v_mfma_f32_16x16x32_bf16 v[64:67], a[32:35], a[208:211], v[64:67]
    ds_read_b128 a[216:219], v34 offset:26624
    ds_read_b128 a[220:223], v34 offset:27648
    v_exp_f32 v128, v128
    v_exp_f32 v129, v129
    v_mfma_f32_16x16x32_bf16 v[68:71], a[36:39], a[192:195], v[68:71]
    ds_read_b128 a[224:227], v34 offset:28672
    ds_read_b128 a[228:231], v34 offset:29696
    v_exp_f32 v130, v130
    v_exp_f32 v131, v131
    v_mfma_f32_16x16x32_bf16 v[72:75], a[36:39], a[196:199], v[72:75]
    s_waitcnt vmcnt(17)
    ds_read_b64_tr_b16 a[64:65], v20 offset:4096
    v_exp_f32 v148, v148
    v_exp_f32 v149, v149
    v_mfma_f32_16x16x32_bf16 v[76:79], a[36:39], a[200:203], v[76:79]
    ds_read_b64_tr_b16 a[66:67], v20 offset:6144
    ds_read_b64_tr_b16 a[68:69], v21 offset:4096
    v_exp_f32 v150, v150
    v_exp_f32 v151, v151
    v_mfma_f32_16x16x32_bf16 v[80:83], a[36:39], a[204:207], v[80:83]
    ds_read_b64_tr_b16 a[70:71], v21 offset:6144
    ds_read_b64_tr_b16 a[72:73], v22 offset:4096
    v_cvt_pk_bf16_f32 v128, v128, v129
    v_cvt_pk_bf16_f32 v129, v130, v131
    v_mfma_f32_16x16x32_bf16 v[84:87], a[36:39], a[208:211], v[84:87]
    ds_read_b64_tr_b16 a[74:75], v22 offset:6144
    ds_read_b64_tr_b16 a[76:77], v23 offset:4096
    v_cvt_pk_bf16_f32 v130, v148, v149
    v_cvt_pk_bf16_f32 v131, v150, v151
    v_mfma_f32_16x16x32_bf16 v[88:91], a[40:43], a[192:195], v[88:91]
    ds_read_b64_tr_b16 a[78:79], v23 offset:6144
    v_fma_f32 v132, v132, s37, -v36
    v_fma_f32 v133, v133, s37, -v36
    v_fma_f32 v134, v134, s37, -v36
    v_mfma_f32_16x16x32_bf16 v[92:95], a[40:43], a[196:199], v[92:95]
    v_fma_f32 v135, v135, s37, -v36
    v_fma_f32 v152, v152, s37, -v36
    v_fma_f32 v153, v153, s37, -v36
    v_fma_f32 v154, v154, s37, -v36
    v_mfma_f32_16x16x32_bf16 v[96:99], a[40:43], a[200:203], v[96:99]
    v_fma_f32 v155, v155, s37, -v36
    v_exp_f32 v132, v132
    v_exp_f32 v133, v133
    v_exp_f32 v134, v134
    v_mfma_f32_16x16x32_bf16 v[100:103], a[40:43], a[204:207], v[100:103]
    v_exp_f32 v135, v135
    v_exp_f32 v152, v152
    v_exp_f32 v153, v153
    v_exp_f32 v154, v154
    v_mfma_f32_16x16x32_bf16 v[104:107], a[40:43], a[208:211], v[104:107]
    v_exp_f32 v155, v155
    v_mfma_f32_16x16x32_bf16 v[228:231], a[252:255], v[128:131], v[228:231]
    v_cvt_pk_bf16_f32 v132, v132, v133
    v_cvt_pk_bf16_f32 v133, v134, v135
    v_mfma_f32_16x16x32_bf16 v[108:111], a[44:47], a[192:195], v[108:111]
    v_cvt_pk_bf16_f32 v134, v152, v153
    v_cvt_pk_bf16_f32 v135, v154, v155
    v_fma_f32 v136, v136, s37, -v37
    v_fma_f32 v137, v137, s37, -v37
    v_mfma_f32_16x16x32_bf16 v[112:115], a[44:47], a[196:199], v[112:115]
    v_fma_f32 v138, v138, s37, -v37
    v_fma_f32 v139, v139, s37, -v37
    v_fma_f32 v156, v156, s37, -v37
    v_fma_f32 v157, v157, s37, -v37
    v_mfma_f32_16x16x32_bf16 v[116:119], a[44:47], a[200:203], v[116:119]
    v_fma_f32 v158, v158, s37, -v37
    v_fma_f32 v159, v159, s37, -v37
    v_exp_f32 v136, v136
    v_exp_f32 v137, v137
    v_mfma_f32_16x16x32_bf16 v[120:123], a[44:47], a[204:207], v[120:123]
    v_exp_f32 v138, v138
    v_exp_f32 v139, v139
    v_exp_f32 v156, v156
    v_mfma_f32_16x16x32_bf16 v[124:127], a[44:47], a[208:211], v[124:127]
    s_waitcnt lgkmcnt(8)
    v_mfma_f32_16x16x32_bf16 v[48:51], a[48:51], a[212:215], v[48:51]
    s_waitcnt lgkmcnt(0)
    s_add_u32 m0, s33, 4096
    v_exp_f32 v157, v157
    v_exp_f32 v158, v158
    v_mfma_f32_16x16x32_bf16 v[52:55], a[48:51], a[216:219], v[52:55]
    s_xor_b32 s34, s101, 49152
    buffer_load_dwordx4 v4, s[20:23], s34 offen offset:0 nt lds
    v_exp_f32 v159, v159
    v_mfma_f32_16x16x32_bf16 v[232:235], a[252:255], v[132:135], v[232:235]
    v_mfma_f32_16x16x32_bf16 v[56:59], a[48:51], a[220:223], v[56:59]
    buffer_load_dwordx4 v5, s[20:23], s34 offen offset:1024 nt lds
    buffer_load_dwordx4 v6, s[20:23], s34 offen offset:2048 nt lds
    v_cvt_pk_bf16_f32 v136, v136, v137
    v_cvt_pk_bf16_f32 v137, v138, v139
    v_mfma_f32_16x16x32_bf16 v[60:63], a[48:51], a[224:227], v[60:63]
    buffer_load_dwordx4 v7, s[20:23], s34 offen offset:3072 nt lds
    ds_read_b128 a[192:195], v3 offset:0
    v_cvt_pk_bf16_f32 v138, v156, v157
    v_cvt_pk_bf16_f32 v139, v158, v159
    v_mfma_f32_16x16x32_bf16 v[64:67], a[48:51], a[228:231], v[64:67]
    ds_read_b128 a[196:199], v3 offset:1024
    ds_read_b128 a[200:203], v3 offset:2048
    v_fma_f32 v140, v140, s37, -v38
    v_fma_f32 v141, v141, s37, -v38
    v_mfma_f32_16x16x32_bf16 v[68:71], a[52:55], a[212:215], v[68:71]
    ds_read_b128 a[204:207], v3 offset:3072
    ds_read_b128 a[208:211], v3 offset:4096
    v_fma_f32 v142, v142, s37, -v38
    v_fma_f32 v143, v143, s37, -v38
    v_mfma_f32_16x16x32_bf16 v[72:75], a[52:55], a[216:219], v[72:75]
    s_waitcnt vmcnt(17)
    ds_read_b64_tr_b16 a[80:81], v20 offset:12288
    v_fma_f32 v160, v160, s37, -v38
    v_fma_f32 v161, v161, s37, -v38
    v_mfma_f32_16x16x32_bf16 v[76:79], a[52:55], a[220:223], v[76:79]
    ds_read_b64_tr_b16 a[82:83], v20 offset:14336
    ds_read_b64_tr_b16 a[84:85], v21 offset:12288
    v_fma_f32 v162, v162, s37, -v38
    v_fma_f32 v163, v163, s37, -v38
    v_mfma_f32_16x16x32_bf16 v[80:83], a[52:55], a[224:227], v[80:83]
    ds_read_b64_tr_b16 a[86:87], v21 offset:14336
    ds_read_b64_tr_b16 a[88:89], v22 offset:12288
    v_exp_f32 v140, v140
    v_exp_f32 v141, v141
    v_mfma_f32_16x16x32_bf16 v[84:87], a[52:55], a[228:231], v[84:87]
    ds_read_b64_tr_b16 a[90:91], v22 offset:14336
    ds_read_b64_tr_b16 a[92:93], v23 offset:12288
    v_exp_f32 v142, v142
    v_exp_f32 v143, v143
    v_mfma_f32_16x16x32_bf16 v[88:91], a[56:59], a[212:215], v[88:91]
    ds_read_b64_tr_b16 a[94:95], v23 offset:14336
    v_exp_f32 v160, v160
    v_exp_f32 v161, v161
    v_exp_f32 v162, v162
    v_mfma_f32_16x16x32_bf16 v[92:95], a[56:59], a[216:219], v[92:95]
    v_exp_f32 v163, v163
    v_mfma_f32_16x16x32_bf16 v[236:239], a[252:255], v[136:139], v[236:239]
    v_cvt_pk_bf16_f32 v140, v140, v141
    v_cvt_pk_bf16_f32 v141, v142, v143
    v_mfma_f32_16x16x32_bf16 v[96:99], a[56:59], a[220:223], v[96:99]
    ds_write_b128 v31, v[128:131] offset:10240
    v_cvt_pk_bf16_f32 v142, v160, v161
    v_cvt_pk_bf16_f32 v143, v162, v163
    v_fma_f32 v144, v144, s37, -v39
    v_mfma_f32_16x16x32_bf16 v[100:103], a[56:59], a[224:227], v[100:103]
    v_fma_f32 v145, v145, s37, -v39
    v_fma_f32 v146, v146, s37, -v39
    v_fma_f32 v147, v147, s37, -v39
    v_fma_f32 v164, v164, s37, -v39
    v_mfma_f32_16x16x32_bf16 v[104:107], a[56:59], a[228:231], v[104:107]
    ds_write_b128 v31, v[132:135] offset:11264
    v_fma_f32 v165, v165, s37, -v39
    v_fma_f32 v166, v166, s37, -v39
    v_fma_f32 v167, v167, s37, -v39
    v_mfma_f32_16x16x32_bf16 v[108:111], a[60:63], a[212:215], v[108:111]
    v_exp_f32 v144, v144
    v_exp_f32 v145, v145
    v_exp_f32 v146, v146
    v_exp_f32 v147, v147
    v_mfma_f32_16x16x32_bf16 v[112:115], a[60:63], a[216:219], v[112:115]
    v_exp_f32 v164, v164
    v_exp_f32 v165, v165
    v_exp_f32 v166, v166
    v_exp_f32 v167, v167
    v_mfma_f32_16x16x32_bf16 v[116:119], a[60:63], a[220:223], v[116:119]
    v_mfma_f32_16x16x32_bf16 v[240:243], a[252:255], v[140:143], v[240:243]
    v_cvt_pk_bf16_f32 v144, v144, v145
    v_cvt_pk_bf16_f32 v145, v146, v147
    v_cvt_pk_bf16_f32 v146, v164, v165
    v_mfma_f32_16x16x32_bf16 v[120:123], a[60:63], a[224:227], v[120:123]
    v_cvt_pk_bf16_f32 v147, v166, v167
    s_nop 1
    v_mfma_f32_16x16x32_bf16 v[244:247], a[252:255], v[144:147], v[244:247]
    v_fma_f32 v168, v168, s37, -v35
    v_mfma_f32_16x16x32_bf16 v[124:127], a[60:63], a[228:231], v[124:127]
    s_waitcnt lgkmcnt(10)
    v_mfma_f32_16x16x32_bf16 v[48:51], a[64:67], a[192:195], v[48:51]
    s_waitcnt lgkmcnt(2)
    s_add_u32 m0, s33, 12288
    v_fma_f32 v169, v169, s37, -v35
    v_fma_f32 v170, v170, s37, -v35
    v_mfma_f32_16x16x32_bf16 v[52:55], a[64:67], a[196:199], v[52:55]
    s_xor_b32 s34, s101, 98304
    buffer_load_dwordx4 v4, s[20:23], s34 offen offset:0 nt lds
    v_fma_f32 v171, v171, s37, -v35
    v_fma_f32 v188, v188, s37, -v35
    v_mfma_f32_16x16x32_bf16 v[56:59], a[64:67], a[200:203], v[56:59]
    buffer_load_dwordx4 v5, s[20:23], s34 offen offset:1024 nt lds
    buffer_load_dwordx4 v6, s[20:23], s34 offen offset:2048 nt lds
    v_fma_f32 v189, v189, s37, -v35
    v_fma_f32 v190, v190, s37, -v35
    v_mfma_f32_16x16x32_bf16 v[60:63], a[64:67], a[204:207], v[60:63]
    buffer_load_dwordx4 v7, s[20:23], s34 offen offset:3072 nt lds
    ds_read_b128 a[212:215], v3 offset:5120
    v_fma_f32 v191, v191, s37, -v35
    v_exp_f32 v168, v168
    v_mfma_f32_16x16x32_bf16 v[64:67], a[64:67], a[208:211], v[64:67]
    ds_read_b128 a[216:219], v3 offset:6144
    ds_read_b128 a[220:223], v3 offset:7168
    v_exp_f32 v169, v169
    v_exp_f32 v170, v170
    v_mfma_f32_16x16x32_bf16 v[68:71], a[68:71], a[192:195], v[68:71]
    ds_read_b128 a[224:227], v3 offset:8192
    ds_read_b128 a[228:231], v3 offset:9216
    v_exp_f32 v171, v171
    v_exp_f32 v188, v188
    v_mfma_f32_16x16x32_bf16 v[72:75], a[68:71], a[196:199], v[72:75]
    s_waitcnt vmcnt(16)
    ds_read_b64_tr_b16 a[96:97], v20 offset:8192
    v_exp_f32 v189, v189
    v_exp_f32 v190, v190
    v_mfma_f32_16x16x32_bf16 v[76:79], a[68:71], a[200:203], v[76:79]
    ds_read_b64_tr_b16 a[98:99], v20 offset:10240
    ds_read_b64_tr_b16 a[100:101], v21 offset:8192
    v_exp_f32 v191, v191
    v_cvt_pk_bf16_f32 v168, v168, v169
    v_mfma_f32_16x16x32_bf16 v[80:83], a[68:71], a[204:207], v[80:83]
    ds_read_b64_tr_b16 a[102:103], v21 offset:10240
    ds_read_b64_tr_b16 a[104:105], v22 offset:8192
    v_cvt_pk_bf16_f32 v169, v170, v171
    v_cvt_pk_bf16_f32 v170, v188, v189
    v_mfma_f32_16x16x32_bf16 v[84:87], a[68:71], a[208:211], v[84:87]
    ds_read_b64_tr_b16 a[106:107], v22 offset:10240
    ds_read_b64_tr_b16 a[108:109], v23 offset:8192
    v_cvt_pk_bf16_f32 v171, v190, v191
    v_fma_f32 v172, v172, s37, -v36
    v_mfma_f32_16x16x32_bf16 v[88:91], a[72:75], a[192:195], v[88:91]
    ds_read_b64_tr_b16 a[110:111], v23 offset:10240
    v_fma_f32 v173, v173, s37, -v36
    v_fma_f32 v174, v174, s37, -v36
    v_fma_f32 v175, v175, s37, -v36
    v_mfma_f32_16x16x32_bf16 v[92:95], a[72:75], a[196:199], v[92:95]
    v_fma_f32 v192, v192, s37, -v36
    v_fma_f32 v193, v193, s37, -v36
    v_fma_f32 v194, v194, s37, -v36
    v_fma_f32 v195, v195, s37, -v36
    v_mfma_f32_16x16x32_bf16 v[96:99], a[72:75], a[200:203], v[96:99]
    ds_write_b128 v31, v[136:139] offset:12288
    v_exp_f32 v172, v172
    v_exp_f32 v173, v173
    v_exp_f32 v174, v174
    v_mfma_f32_16x16x32_bf16 v[100:103], a[72:75], a[204:207], v[100:103]
    v_exp_f32 v175, v175
    v_exp_f32 v192, v192
    v_exp_f32 v193, v193
    v_exp_f32 v194, v194
    v_mfma_f32_16x16x32_bf16 v[104:107], a[72:75], a[208:211], v[104:107]
    ds_write_b128 v31, v[140:143] offset:13312
    v_exp_f32 v195, v195
    v_mfma_f32_16x16x32_bf16 v[228:231], a[252:255], v[168:171], v[228:231]
    v_cvt_pk_bf16_f32 v172, v172, v173
    v_mfma_f32_16x16x32_bf16 v[108:111], a[76:79], a[192:195], v[108:111]
    v_cvt_pk_bf16_f32 v173, v174, v175
    v_cvt_pk_bf16_f32 v174, v192, v193
    v_cvt_pk_bf16_f32 v175, v194, v195
    v_fma_f32 v176, v176, s37, -v37
    v_mfma_f32_16x16x32_bf16 v[112:115], a[76:79], a[196:199], v[112:115]
    ds_write_b128 v31, v[144:147] offset:14336
    v_fma_f32 v177, v177, s37, -v37
    v_fma_f32 v178, v178, s37, -v37
    v_fma_f32 v179, v179, s37, -v37
    v_mfma_f32_16x16x32_bf16 v[116:119], a[76:79], a[200:203], v[116:119]
    v_fma_f32 v196, v196, s37, -v37
    v_fma_f32 v197, v197, s37, -v37
    v_fma_f32 v198, v198, s37, -v37
    v_fma_f32 v199, v199, s37, -v37
    v_mfma_f32_16x16x32_bf16 v[120:123], a[76:79], a[204:207], v[120:123]
    v_exp_f32 v176, v176
    v_exp_f32 v177, v177
    v_exp_f32 v178, v178
    v_exp_f32 v179, v179
    v_mfma_f32_16x16x32_bf16 v[124:127], a[76:79], a[208:211], v[124:127]
    v_exp_f32 v196, v196
    s_waitcnt lgkmcnt(11)
    v_mfma_f32_16x16x32_bf16 v[48:51], a[80:83], a[212:215], v[48:51]
    s_waitcnt lgkmcnt(3)
    s_add_u32 m0, s33, 8192
    v_exp_f32 v197, v197
    v_exp_f32 v198, v198
    v_mfma_f32_16x16x32_bf16 v[52:55], a[80:83], a[216:219], v[52:55]
    s_xor_b32 s34, s101, 114688
    buffer_load_dwordx4 v4, s[20:23], s34 offen offset:0 nt lds
    v_exp_f32 v199, v199
    v_mfma_f32_16x16x32_bf16 v[232:235], a[252:255], v[172:175], v[232:235]
    v_mfma_f32_16x16x32_bf16 v[56:59], a[80:83], a[220:223], v[56:59]
    buffer_load_dwordx4 v5, s[20:23], s34 offen offset:1024 nt lds
    buffer_load_dwordx4 v6, s[20:23], s34 offen offset:2048 nt lds
    v_cvt_pk_bf16_f32 v176, v176, v177
    v_cvt_pk_bf16_f32 v177, v178, v179
    v_mfma_f32_16x16x32_bf16 v[60:63], a[80:83], a[224:227], v[60:63]
    buffer_load_dwordx4 v7, s[20:23], s34 offen offset:3072 nt lds
    ds_read_b128 a[192:195], v3 offset:20480
    v_cvt_pk_bf16_f32 v178, v196, v197
    v_cvt_pk_bf16_f32 v179, v198, v199
    v_mfma_f32_16x16x32_bf16 v[64:67], a[80:83], a[228:231], v[64:67]
    ds_read_b128 a[196:199], v3 offset:21504
    ds_read_b128 a[200:203], v3 offset:22528
    v_fma_f32 v180, v180, s37, -v38
    v_fma_f32 v181, v181, s37, -v38
    v_mfma_f32_16x16x32_bf16 v[68:71], a[84:87], a[212:215], v[68:71]
    ds_read_b128 a[204:207], v3 offset:23552
    ds_read_b128 a[208:211], v3 offset:24576
    v_fma_f32 v182, v182, s37, -v38
    v_fma_f32 v183, v183, s37, -v38
    v_mfma_f32_16x16x32_bf16 v[72:75], a[84:87], a[216:219], v[72:75]
    s_waitcnt vmcnt(16)
    ds_read_b64_tr_b16 a[112:113], v20 offset:0
    v_fma_f32 v200, v200, s37, -v38
    v_fma_f32 v201, v201, s37, -v38
    v_mfma_f32_16x16x32_bf16 v[76:79], a[84:87], a[220:223], v[76:79]
    ds_read_b64_tr_b16 a[114:115], v20 offset:2048
    ds_read_b64_tr_b16 a[116:117], v21 offset:0
    v_fma_f32 v202, v202, s37, -v38
    v_fma_f32 v203, v203, s37, -v38
    v_mfma_f32_16x16x32_bf16 v[80:83], a[84:87], a[224:227], v[80:83]
    ds_read_b64_tr_b16 a[118:119], v21 offset:2048
    ds_read_b64_tr_b16 a[120:121], v22 offset:0
    v_exp_f32 v180, v180
    v_exp_f32 v181, v181
    v_mfma_f32_16x16x32_bf16 v[84:87], a[84:87], a[228:231], v[84:87]
    ds_read_b64_tr_b16 a[122:123], v22 offset:2048
    ds_read_b64_tr_b16 a[124:125], v23 offset:0
    v_exp_f32 v182, v182
    v_exp_f32 v183, v183
    v_mfma_f32_16x16x32_bf16 v[88:91], a[88:91], a[212:215], v[88:91]
    ds_read_b64_tr_b16 a[126:127], v23 offset:2048
    v_exp_f32 v200, v200
    v_exp_f32 v201, v201
    v_exp_f32 v202, v202
    v_mfma_f32_16x16x32_bf16 v[92:95], a[88:91], a[216:219], v[92:95]
    v_exp_f32 v203, v203
    v_mfma_f32_16x16x32_bf16 v[236:239], a[252:255], v[176:179], v[236:239]
    v_cvt_pk_bf16_f32 v180, v180, v181
    v_cvt_pk_bf16_f32 v181, v182, v183
    v_mfma_f32_16x16x32_bf16 v[96:99], a[88:91], a[220:223], v[96:99]
    ds_write_b128 v31, v[168:171] offset:15360
    v_cvt_pk_bf16_f32 v182, v200, v201
    v_cvt_pk_bf16_f32 v183, v202, v203
    v_fma_f32 v184, v184, s37, -v39
    v_mfma_f32_16x16x32_bf16 v[100:103], a[88:91], a[224:227], v[100:103]
    v_fma_f32 v185, v185, s37, -v39
    v_fma_f32 v186, v186, s37, -v39
    v_fma_f32 v187, v187, s37, -v39
    v_fma_f32 v204, v204, s37, -v39
    v_mfma_f32_16x16x32_bf16 v[104:107], a[88:91], a[228:231], v[104:107]
    ds_write_b128 v31, v[172:175] offset:16384
    v_fma_f32 v205, v205, s37, -v39
    v_fma_f32 v206, v206, s37, -v39
    v_fma_f32 v207, v207, s37, -v39
    v_mfma_f32_16x16x32_bf16 v[108:111], a[92:95], a[212:215], v[108:111]
    v_exp_f32 v184, v184
    v_exp_f32 v185, v185
    v_exp_f32 v186, v186
    v_exp_f32 v187, v187
    v_mfma_f32_16x16x32_bf16 v[112:115], a[92:95], a[216:219], v[112:115]
    v_exp_f32 v204, v204
    v_exp_f32 v205, v205
    v_exp_f32 v206, v206
    v_exp_f32 v207, v207
    v_mfma_f32_16x16x32_bf16 v[116:119], a[92:95], a[220:223], v[116:119]
    v_mfma_f32_16x16x32_bf16 v[240:243], a[252:255], v[180:183], v[240:243]
    v_cvt_pk_bf16_f32 v184, v184, v185
    v_cvt_pk_bf16_f32 v185, v186, v187
    v_cvt_pk_bf16_f32 v186, v204, v205
    v_mfma_f32_16x16x32_bf16 v[120:123], a[92:95], a[224:227], v[120:123]
    v_cvt_pk_bf16_f32 v187, v206, v207
    s_nop 1
    v_mfma_f32_16x16x32_bf16 v[244:247], a[252:255], v[184:187], v[244:247]
    v_mfma_f32_16x16x32_bf16 v[124:127], a[92:95], a[228:231], v[124:127]
    s_waitcnt lgkmcnt(10)
    v_mfma_f32_16x16x32_bf16 v[48:51], a[96:99], a[192:195], v[48:51]
    s_waitcnt lgkmcnt(2)
    s_add_u32 m0, s33, 0
    v_mfma_f32_16x16x32_bf16 v[52:55], a[96:99], a[196:199], v[52:55]
    s_xor_b32 s34, s101, 163840
    buffer_load_dwordx4 v4, s[20:23], s34 offen offset:0 nt lds
    v_mfma_f32_16x16x32_bf16 v[56:59], a[96:99], a[200:203], v[56:59]
    buffer_load_dwordx4 v5, s[20:23], s34 offen offset:1024 nt lds
    buffer_load_dwordx4 v6, s[20:23], s34 offen offset:2048 nt lds
    v_mfma_f32_16x16x32_bf16 v[60:63], a[96:99], a[204:207], v[60:63]
    buffer_load_dwordx4 v7, s[20:23], s34 offen offset:3072 nt lds
    ds_read_b128 a[212:215], v3 offset:25600
    v_mfma_f32_16x16x32_bf16 v[64:67], a[96:99], a[208:211], v[64:67]
    ds_read_b128 a[216:219], v3 offset:26624
    ds_read_b128 a[220:223], v3 offset:27648
    v_mfma_f32_16x16x32_bf16 v[68:71], a[100:103], a[192:195], v[68:71]
    ds_read_b128 a[224:227], v3 offset:28672
    ds_read_b128 a[228:231], v3 offset:29696
    v_mfma_f32_16x16x32_bf16 v[72:75], a[100:103], a[196:199], v[72:75]
    s_waitcnt vmcnt(16)
    ds_read_b64_tr_b16 a[128:129], v20 offset:16384
    v_mfma_f32_16x16x32_bf16 v[76:79], a[100:103], a[200:203], v[76:79]
    ds_read_b64_tr_b16 a[130:131], v20 offset:18432
    ds_read_b64_tr_b16 a[132:133], v21 offset:16384
    v_mfma_f32_16x16x32_bf16 v[80:83], a[100:103], a[204:207], v[80:83]
    ds_read_b64_tr_b16 a[134:135], v21 offset:18432
    ds_read_b64_tr_b16 a[136:137], v22 offset:16384
    v_mfma_f32_16x16x32_bf16 v[84:87], a[100:103], a[208:211], v[84:87]
    ds_read_b64_tr_b16 a[138:139], v22 offset:18432
    ds_read_b64_tr_b16 a[140:141], v23 offset:16384
    v_mfma_f32_16x16x32_bf16 v[88:91], a[104:107], a[192:195], v[88:91]
    ds_read_b64_tr_b16 a[142:143], v23 offset:18432
    v_mfma_f32_16x16x32_bf16 v[92:95], a[104:107], a[196:199], v[92:95]
    v_mfma_f32_16x16x32_bf16 v[96:99], a[104:107], a[200:203], v[96:99]
    ds_write_b128 v31, v[176:179] offset:17408
    v_mfma_f32_16x16x32_bf16 v[100:103], a[104:107], a[204:207], v[100:103]
    v_mfma_f32_16x16x32_bf16 v[104:107], a[104:107], a[208:211], v[104:107]
    ds_write_b128 v31, v[180:183] offset:18432
    v_mfma_f32_16x16x32_bf16 v[108:111], a[108:111], a[192:195], v[108:111]
    v_mfma_f32_16x16x32_bf16 v[112:115], a[108:111], a[196:199], v[112:115]
    ds_write_b128 v31, v[184:187] offset:19456
    v_mfma_f32_16x16x32_bf16 v[116:119], a[108:111], a[200:203], v[116:119]
    v_mfma_f32_16x16x32_bf16 v[120:123], a[108:111], a[204:207], v[120:123]
    v_mfma_f32_16x16x32_bf16 v[124:127], a[108:111], a[208:211], v[124:127]
    s_waitcnt lgkmcnt(11)
    v_mfma_f32_16x16x32_bf16 v[48:51], a[112:115], a[212:215], v[48:51]
    s_waitcnt lgkmcnt(0)
    s_barrier
    s_add_u32 m0, s33, 16384
    v_mfma_f32_16x16x32_bf16 v[52:55], a[112:115], a[216:219], v[52:55]
    s_xor_b32 s34, s101, 180224
    buffer_load_dwordx4 v4, s[20:23], s34 offen offset:0 nt lds
    buffer_load_dwordx4 v5, s[20:23], s34 offen offset:1024 nt lds
    v_mfma_f32_16x16x32_bf16 v[56:59], a[112:115], a[220:223], v[56:59]
    buffer_load_dwordx4 v6, s[20:23], s34 offen offset:2048 nt lds
    buffer_load_dwordx4 v7, s[20:23], s34 offen offset:3072 nt lds
    ds_read_b128 a[192:195], v34 offset:10240
    v_mfma_f32_16x16x32_bf16 v[60:63], a[112:115], a[224:227], v[60:63]
    ds_read_b128 a[196:199], v34 offset:11264
    ds_read_b128 a[200:203], v34 offset:12288
    ds_read_b128 a[204:207], v34 offset:13312
    v_mfma_f32_16x16x32_bf16 v[64:67], a[112:115], a[228:231], v[64:67]
    ds_read_b128 a[208:211], v34 offset:14336
    v_mul_f32 v48, v40, v48
    v_mul_f32 v49, v40, v49
    v_mul_f32 v50, v40, v50
    v_mul_f32 v51, v40, v51
    v_mfma_f32_16x16x32_bf16 v[68:71], a[116:119], a[212:215], v[68:71]
    s_waitcnt vmcnt(16)
    v_mul_f32 v52, v41, v52
    v_mul_f32 v53, v41, v53
    v_mul_f32 v54, v41, v54
    v_mul_f32 v55, v41, v55
    v_mfma_f32_16x16x32_bf16 v[72:75], a[116:119], a[216:219], v[72:75]
    ds_read_b64_tr_b16 a[144:145], v20 offset:4096
    v_mul_f32 v56, v42, v56
    v_mul_f32 v57, v42, v57
    v_mul_f32 v58, v42, v58
    v_mul_f32 v59, v42, v59
    v_mfma_f32_16x16x32_bf16 v[76:79], a[116:119], a[220:223], v[76:79]
    ds_read_b64_tr_b16 a[146:147], v20 offset:6144
    v_mul_f32 v60, v43, v60
    v_mul_f32 v61, v43, v61
    v_mul_f32 v62, v43, v62
    v_mul_f32 v63, v43, v63
    v_mfma_f32_16x16x32_bf16 v[80:83], a[116:119], a[224:227], v[80:83]
    ds_read_b64_tr_b16 a[148:149], v21 offset:4096
    v_mul_f32 v64, v44, v64
    v_mul_f32 v65, v44, v65
    v_mul_f32 v66, v44, v66
    v_mul_f32 v67, v44, v67
    v_mfma_f32_16x16x32_bf16 v[84:87], a[116:119], a[228:231], v[84:87]
    ds_read_b64_tr_b16 a[150:151], v21 offset:6144
    v_mul_f32 v68, v40, v68
    v_mul_f32 v69, v40, v69
    v_mul_f32 v70, v40, v70
    v_mul_f32 v71, v40, v71
    v_mfma_f32_16x16x32_bf16 v[88:91], a[120:123], a[212:215], v[88:91]
    ds_read_b64_tr_b16 a[152:153], v22 offset:4096
    v_mul_f32 v72, v41, v72
    v_mul_f32 v73, v41, v73
    v_mul_f32 v74, v41, v74
    v_mul_f32 v75, v41, v75
    v_mfma_f32_16x16x32_bf16 v[92:95], a[120:123], a[216:219], v[92:95]
    ds_read_b64_tr_b16 a[154:155], v22 offset:6144
    v_mul_f32 v76, v42, v76
    v_mul_f32 v77, v42, v77
    v_mul_f32 v78, v42, v78
    v_mul_f32 v79, v42, v79
    v_mfma_f32_16x16x32_bf16 v[96:99], a[120:123], a[220:223], v[96:99]
    ds_read_b64_tr_b16 a[156:157], v23 offset:4096
    v_mul_f32 v80, v43, v80
    v_mul_f32 v81, v43, v81
    v_mul_f32 v82, v43, v82
    v_mul_f32 v83, v43, v83
    v_mfma_f32_16x16x32_bf16 v[100:103], a[120:123], a[224:227], v[100:103]
    ds_read_b64_tr_b16 a[158:159], v23 offset:6144
    v_mul_f32 v84, v44, v84
    v_mul_f32 v85, v44, v85
    v_mul_f32 v86, v44, v86
    v_mul_f32 v87, v44, v87
    v_mfma_f32_16x16x32_bf16 v[104:107], a[120:123], a[228:231], v[104:107]
    v_mul_f32 v88, v40, v88
    v_mul_f32 v89, v40, v89
    v_mul_f32 v90, v40, v90
    v_mul_f32 v91, v40, v91
    v_mfma_f32_16x16x32_bf16 v[108:111], a[124:127], a[212:215], v[108:111]
    v_mul_f32 v92, v41, v92
    v_mul_f32 v93, v41, v93
    v_mul_f32 v94, v41, v94
    v_mul_f32 v95, v41, v95
    v_mfma_f32_16x16x32_bf16 v[112:115], a[124:127], a[216:219], v[112:115]
    v_mul_f32 v96, v42, v96
    v_mul_f32 v97, v42, v97
    v_mul_f32 v98, v42, v98
    v_mul_f32 v99, v42, v99
    v_mfma_f32_16x16x32_bf16 v[116:119], a[124:127], a[220:223], v[116:119]
    v_mul_f32 v100, v43, v100
    v_mul_f32 v101, v43, v101
    v_mul_f32 v102, v43, v102
    v_mul_f32 v103, v43, v103
    v_mfma_f32_16x16x32_bf16 v[120:123], a[124:127], a[224:227], v[120:123]
    v_mul_f32 v104, v44, v104
    v_mul_f32 v105, v44, v105
    v_mul_f32 v106, v44, v106
    v_mul_f32 v107, v44, v107
    v_mfma_f32_16x16x32_bf16 v[124:127], a[124:127], a[228:231], v[124:127]
    v_mul_f32 v108, v40, v108
    v_mul_f32 v109, v40, v109
    v_mul_f32 v110, v40, v110
    v_mul_f32 v111, v40, v111
    s_waitcnt lgkmcnt(8)
    v_mfma_f32_16x16x32_bf16 v[48:51], a[128:131], a[192:195], v[48:51]
    s_waitcnt lgkmcnt(0)
    s_add_u32 m0, s33, 4096
    v_mfma_f32_16x16x32_bf16 v[52:55], a[128:131], a[196:199], v[52:55]
    s_xor_b32 s34, s101, 229376
    buffer_load_dwordx4 v4, s[20:23], s34 offen offset:0 nt lds
    v_mfma_f32_16x16x32_bf16 v[56:59], a[128:131], a[200:203], v[56:59]
    buffer_load_dwordx4 v5, s[20:23], s34 offen offset:1024 nt lds
    buffer_load_dwordx4 v6, s[20:23], s34 offen offset:2048 nt lds
    v_mul_f32 v112, v41, v112
    v_mfma_f32_16x16x32_bf16 v[60:63], a[128:131], a[204:207], v[60:63]
    buffer_load_dwordx4 v7, s[20:23], s34 offen offset:3072 nt lds
    ds_read_b128 a[212:215], v34 offset:15360
    v_mul_f32 v113, v41, v113
    v_mfma_f32_16x16x32_bf16 v[64:67], a[128:131], a[208:211], v[64:67]
    ds_read_b128 a[216:219], v34 offset:16384
    ds_read_b128 a[220:223], v34 offset:17408
    v_mul_f32 v114, v41, v114
    v_mfma_f32_16x16x32_bf16 v[68:71], a[132:135], a[192:195], v[68:71]
    ds_read_b128 a[224:227], v34 offset:18432
    ds_read_b128 a[228:231], v34 offset:19456
    v_mul_f32 v115, v41, v115
    v_mfma_f32_16x16x32_bf16 v[72:75], a[132:135], a[196:199], v[72:75]
    s_waitcnt vmcnt(16)
    ds_read_b64_tr_b16 a[0:1], v20 offset:12288
    v_mul_f32 v116, v42, v116
    v_mfma_f32_16x16x32_bf16 v[76:79], a[132:135], a[200:203], v[76:79]
    ds_read_b64_tr_b16 a[2:3], v20 offset:14336
    ds_read_b64_tr_b16 a[4:5], v21 offset:12288
    v_mul_f32 v117, v42, v117
    v_mfma_f32_16x16x32_bf16 v[80:83], a[132:135], a[204:207], v[80:83]
    ds_read_b64_tr_b16 a[6:7], v21 offset:14336
    ds_read_b64_tr_b16 a[8:9], v22 offset:12288
    v_mul_f32 v118, v42, v118
    v_mfma_f32_16x16x32_bf16 v[84:87], a[132:135], a[208:211], v[84:87]
    ds_read_b64_tr_b16 a[10:11], v22 offset:14336
    ds_read_b64_tr_b16 a[12:13], v23 offset:12288
    v_mul_f32 v119, v42, v119
    v_mfma_f32_16x16x32_bf16 v[88:91], a[136:139], a[192:195], v[88:91]
    ds_read_b64_tr_b16 a[14:15], v23 offset:14336
    v_mul_f32 v120, v43, v120
    v_mul_f32 v121, v43, v121
    v_mfma_f32_16x16x32_bf16 v[92:95], a[136:139], a[196:199], v[92:95]
    v_mul_f32 v122, v43, v122
    v_mul_f32 v123, v43, v123
    v_mul_f32 v124, v44, v124
    v_mfma_f32_16x16x32_bf16 v[96:99], a[136:139], a[200:203], v[96:99]
    ds_write_b32 v32, v228 offset:8192
    v_mul_f32 v125, v44, v125
    v_mul_f32 v126, v44, v126
    v_mfma_f32_16x16x32_bf16 v[100:103], a[136:139], a[204:207], v[100:103]
    v_mul_f32 v127, v44, v127
    v_mfma_f32_16x16x32_bf16 v[104:107], a[136:139], a[208:211], v[104:107]
    ds_write_b32 v32, v232 offset:8448
    v_mfma_f32_16x16x32_bf16 v[108:111], a[140:143], a[192:195], v[108:111]
    v_mfma_f32_16x16x32_bf16 v[112:115], a[140:143], a[196:199], v[112:115]
    ds_write_b32 v32, v236 offset:8704
    v_mfma_f32_16x16x32_bf16 v[116:119], a[140:143], a[200:203], v[116:119]
    v_mfma_f32_16x16x32_bf16 v[120:123], a[140:143], a[204:207], v[120:123]
    v_mfma_f32_16x16x32_bf16 v[124:127], a[140:143], a[208:211], v[124:127]
    s_waitcnt lgkmcnt(11)
    v_mfma_f32_16x16x32_bf16 v[48:51], a[144:147], a[212:215], v[48:51]
    s_waitcnt lgkmcnt(3)
    s_add_u32 m0, s33, 12288
    v_mfma_f32_16x16x32_bf16 v[52:55], a[144:147], a[216:219], v[52:55]
    s_xor_b32 s34, s101, 245760
    buffer_load_dwordx4 v4, s[20:23], s34 offen offset:0 nt lds
    v_mfma_f32_16x16x32_bf16 v[56:59], a[144:147], a[220:223], v[56:59]
    buffer_load_dwordx4 v5, s[20:23], s34 offen offset:1024 nt lds
    buffer_load_dwordx4 v6, s[20:23], s34 offen offset:2048 nt lds
    v_mfma_f32_16x16x32_bf16 v[60:63], a[144:147], a[224:227], v[60:63]
    buffer_load_dwordx4 v7, s[20:23], s34 offen offset:3072 nt lds
    ds_read_b128 a[192:195], v34 offset:30720
    v_mfma_f32_16x16x32_bf16 v[64:67], a[144:147], a[228:231], v[64:67]
    ds_read_b128 a[196:199], v34 offset:31744
    ds_read_b128 a[200:203], v34 offset:32768
    v_mfma_f32_16x16x32_bf16 v[68:71], a[148:151], a[212:215], v[68:71]
    ds_read_b128 a[204:207], v34 offset:33792
    ds_read_b128 a[208:211], v34 offset:34816
    v_mfma_f32_16x16x32_bf16 v[72:75], a[148:151], a[216:219], v[72:75]
    s_waitcnt vmcnt(16)
    ds_read_b64_tr_b16 a[16:17], v20 offset:8192
    v_mfma_f32_16x16x32_bf16 v[76:79], a[148:151], a[220:223], v[76:79]
    ds_read_b64_tr_b16 a[18:19], v20 offset:10240
    ds_read_b64_tr_b16 a[20:21], v21 offset:8192
    v_mfma_f32_16x16x32_bf16 v[80:83], a[148:151], a[224:227], v[80:83]
    ds_read_b64_tr_b16 a[22:23], v21 offset:10240
    ds_read_b64_tr_b16 a[24:25], v22 offset:8192
    v_mfma_f32_16x16x32_bf16 v[84:87], a[148:151], a[228:231], v[84:87]
    ds_read_b64_tr_b16 a[26:27], v22 offset:10240
    ds_read_b64_tr_b16 a[28:29], v23 offset:8192
    v_mfma_f32_16x16x32_bf16 v[88:91], a[152:155], a[212:215], v[88:91]
    ds_read_b64_tr_b16 a[30:31], v23 offset:10240
    s_waitcnt vmcnt(12)
    v_mfma_f32_16x16x32_bf16 v[92:95], a[152:155], a[216:219], v[92:95]
    ds_read_b64_tr_b16 a[32:33], v20 offset:0
    ds_read_b64_tr_b16 a[34:35], v20 offset:2048
    v_mfma_f32_16x16x32_bf16 v[96:99], a[152:155], a[220:223], v[96:99]
    ds_read_b64_tr_b16 a[36:37], v21 offset:0
    ds_read_b64_tr_b16 a[38:39], v21 offset:2048
    v_mfma_f32_16x16x32_bf16 v[100:103], a[152:155], a[224:227], v[100:103]
    ds_write_b32 v32, v240 offset:8960
    ds_read_b64_tr_b16 a[40:41], v22 offset:0
    v_mfma_f32_16x16x32_bf16 v[104:107], a[152:155], a[228:231], v[104:107]
    ds_read_b64_tr_b16 a[42:43], v22 offset:2048
    ds_read_b64_tr_b16 a[44:45], v23 offset:0
    v_mfma_f32_16x16x32_bf16 v[108:111], a[156:159], a[212:215], v[108:111]
    ds_read_b64_tr_b16 a[46:47], v23 offset:2048
    ds_write_b32 v32, v244 offset:9216
    v_mfma_f32_16x16x32_bf16 v[112:115], a[156:159], a[216:219], v[112:115]
    v_mfma_f32_16x16x32_bf16 v[116:119], a[156:159], a[220:223], v[116:119]
    v_mfma_f32_16x16x32_bf16 v[120:123], a[156:159], a[224:227], v[120:123]
    v_mfma_f32_16x16x32_bf16 v[124:127], a[156:159], a[228:231], v[124:127]
    s_waitcnt lgkmcnt(15)
    v_mfma_f32_16x16x32_bf16 v[48:51], a[0:3], a[192:195], v[48:51]
    s_waitcnt lgkmcnt(1)
    s_add_u32 m0, s33, 0
    v_mfma_f32_16x16x32_bf16 v[52:55], a[0:3], a[196:199], v[52:55]
    s_add_u32 s34, s36, 0
    buffer_load_dwordx4 v16, s[24:27], s34 offen offset:0 lds
    v_mfma_f32_16x16x32_bf16 v[56:59], a[0:3], a[200:203], v[56:59]
    buffer_load_dwordx4 v17, s[24:27], s34 offen offset:1024 lds
    buffer_load_dwordx4 v18, s[24:27], s34 offen offset:2048 lds
    v_mfma_f32_16x16x32_bf16 v[60:63], a[0:3], a[204:207], v[60:63]
    buffer_load_dwordx4 v19, s[24:27], s34 offen offset:3072 lds
    s_add_u32 m0, s33, 8192
    v_mfma_f32_16x16x32_bf16 v[64:67], a[0:3], a[208:211], v[64:67]
    s_add_u32 s34, s36, 28672
    buffer_load_dwordx4 v16, s[24:27], s34 offen offset:0 lds
    v_mfma_f32_16x16x32_bf16 v[68:71], a[4:7], a[192:195], v[68:71]
    buffer_load_dwordx4 v17, s[24:27], s34 offen offset:1024 lds
    buffer_load_dwordx4 v18, s[24:27], s34 offen offset:2048 lds
    v_mfma_f32_16x16x32_bf16 v[72:75], a[4:7], a[196:199], v[72:75]
    buffer_load_dwordx4 v19, s[24:27], s34 offen offset:3072 lds
    ds_read_b128 a[212:215], v34 offset:35840
    v_mfma_f32_16x16x32_bf16 v[76:79], a[4:7], a[200:203], v[76:79]
    ds_read_b128 a[216:219], v34 offset:36864
    ds_read_b128 a[220:223], v34 offset:37888
    v_mfma_f32_16x16x32_bf16 v[80:83], a[4:7], a[204:207], v[80:83]
    ds_read_b128 a[224:227], v34 offset:38912
    ds_read_b128 a[228:231], v34 offset:39936
    v_mfma_f32_16x16x32_bf16 v[84:87], a[4:7], a[208:211], v[84:87]
    s_waitcnt vmcnt(16)
    ds_read_b64_tr_b16 a[48:49], v20 offset:16384
    v_mfma_f32_16x16x32_bf16 v[88:91], a[8:11], a[192:195], v[88:91]
    ds_read_b64_tr_b16 a[50:51], v20 offset:18432
    ds_read_b64_tr_b16 a[52:53], v21 offset:16384
    v_mfma_f32_16x16x32_bf16 v[92:95], a[8:11], a[196:199], v[92:95]
    ds_read_b64_tr_b16 a[54:55], v21 offset:18432
    ds_read_b64_tr_b16 a[56:57], v22 offset:16384
    v_mfma_f32_16x16x32_bf16 v[96:99], a[8:11], a[200:203], v[96:99]
    ds_read_b64_tr_b16 a[58:59], v22 offset:18432
    ds_read_b64_tr_b16 a[60:61], v23 offset:16384
    v_mfma_f32_16x16x32_bf16 v[100:103], a[8:11], a[204:207], v[100:103]
    ds_read_b64_tr_b16 a[62:63], v23 offset:18432
    s_waitcnt vmcnt(12)
    v_mfma_f32_16x16x32_bf16 v[104:107], a[8:11], a[208:211], v[104:107]
    ds_read_b64_tr_b16 a[64:65], v20 offset:4096
    ds_read_b64_tr_b16 a[66:67], v20 offset:6144
    v_mfma_f32_16x16x32_bf16 v[108:111], a[12:15], a[192:195], v[108:111]
    ds_read_b64_tr_b16 a[68:69], v21 offset:4096
    ds_read_b64_tr_b16 a[70:71], v21 offset:6144
    v_mfma_f32_16x16x32_bf16 v[112:115], a[12:15], a[196:199], v[112:115]
    ds_read_b64_tr_b16 a[72:73], v22 offset:4096
    ds_read_b64_tr_b16 a[74:75], v22 offset:6144
    v_mfma_f32_16x16x32_bf16 v[116:119], a[12:15], a[200:203], v[116:119]
    ds_read_b64_tr_b16 a[76:77], v23 offset:4096
    ds_read_b64_tr_b16 a[78:79], v23 offset:6144
    v_mfma_f32_16x16x32_bf16 v[120:123], a[12:15], a[204:207], v[120:123]
    v_mfma_f32_16x16x32_bf16 v[124:127], a[12:15], a[208:211], v[124:127]
    s_waitcnt lgkmcnt(15)
    v_mfma_f32_16x16x32_bf16 v[48:51], a[16:19], a[212:215], v[48:51]
    s_waitcnt lgkmcnt(0)
    s_barrier
    v_mfma_f32_16x16x32_bf16 v[52:55], a[16:19], a[216:219], v[52:55]
    s_add_u32 m0, s33, 4096
    s_add_u32 s34, s36, 57344
    v_mfma_f32_16x16x32_bf16 v[56:59], a[16:19], a[220:223], v[56:59]
    buffer_load_dwordx4 v16, s[24:27], s34 offen offset:0 lds
    buffer_load_dwordx4 v17, s[24:27], s34 offen offset:1024 lds
    v_mfma_f32_16x16x32_bf16 v[60:63], a[16:19], a[224:227], v[60:63]
    buffer_load_dwordx4 v18, s[24:27], s34 offen offset:2048 lds
    buffer_load_dwordx4 v19, s[24:27], s34 offen offset:3072 lds
    v_mfma_f32_16x16x32_bf16 v[64:67], a[16:19], a[228:231], v[64:67]
    s_add_u32 m0, s33, 16384
    s_add_u32 s34, s36, 86016
    v_mfma_f32_16x16x32_bf16 v[68:71], a[20:23], a[212:215], v[68:71]
    buffer_load_dwordx4 v16, s[24:27], s34 offen offset:0 lds
    buffer_load_dwordx4 v17, s[24:27], s34 offen offset:1024 lds
    v_mfma_f32_16x16x32_bf16 v[72:75], a[20:23], a[216:219], v[72:75]
    buffer_load_dwordx4 v18, s[24:27], s34 offen offset:2048 lds
    buffer_load_dwordx4 v19, s[24:27], s34 offen offset:3072 lds
    v_mfma_f32_16x16x32_bf16 v[76:79], a[20:23], a[220:223], v[76:79]
    ds_read_b128 a[192:195], v3 offset:10240
    ds_read_b128 a[196:199], v3 offset:11264
    v_mfma_f32_16x16x32_bf16 v[80:83], a[20:23], a[224:227], v[80:83]
    ds_read_b128 a[200:203], v3 offset:12288
    ds_read_b128 a[204:207], v3 offset:13312
    v_mfma_f32_16x16x32_bf16 v[84:87], a[20:23], a[228:231], v[84:87]
    ds_read_b128 a[208:211], v3 offset:14336
    s_waitcnt vmcnt(16)
    v_mfma_f32_16x16x32_bf16 v[88:91], a[24:27], a[212:215], v[88:91]
    ds_read_b64_tr_b16 a[80:81], v20 offset:12288
    ds_read_b64_tr_b16 a[82:83], v20 offset:14336
    v_mfma_f32_16x16x32_bf16 v[92:95], a[24:27], a[216:219], v[92:95]
    ds_read_b64_tr_b16 a[84:85], v21 offset:12288
    ds_read_b64_tr_b16 a[86:87], v21 offset:14336
    v_mfma_f32_16x16x32_bf16 v[96:99], a[24:27], a[220:223], v[96:99]
    ds_read_b64_tr_b16 a[88:89], v22 offset:12288
    ds_read_b64_tr_b16 a[90:91], v22 offset:14336
    v_mfma_f32_16x16x32_bf16 v[100:103], a[24:27], a[224:227], v[100:103]
    ds_read_b64_tr_b16 a[92:93], v23 offset:12288
    ds_read_b64_tr_b16 a[94:95], v23 offset:14336
    v_mfma_f32_16x16x32_bf16 v[104:107], a[24:27], a[228:231], v[104:107]
    v_mfma_f32_16x16x32_bf16 v[108:111], a[28:31], a[212:215], v[108:111]
    v_mfma_f32_16x16x32_bf16 v[112:115], a[28:31], a[216:219], v[112:115]
    v_mfma_f32_16x16x32_bf16 v[116:119], a[28:31], a[220:223], v[116:119]
    v_mfma_f32_16x16x32_bf16 v[120:123], a[28:31], a[224:227], v[120:123]
    v_mfma_f32_16x16x32_bf16 v[124:127], a[28:31], a[228:231], v[124:127]
    s_waitcnt lgkmcnt(8)
    v_mfma_f32_16x16x32_bf16 v[48:51], a[32:35], a[192:195], v[48:51]
    s_waitcnt lgkmcnt(0)
    s_add_u32 m0, s33, 12288
    ds_read_b128 v[208:211], v33 offset:8192
    v_mfma_f32_16x16x32_bf16 v[52:55], a[32:35], a[196:199], v[52:55]
    s_add_u32 s34, s36, 114688
    buffer_load_dwordx4 v16, s[24:27], s34 offen offset:0 lds
    ds_read_b128 v[212:215], v33 offset:8448
    v_mfma_f32_16x16x32_bf16 v[56:59], a[32:35], a[200:203], v[56:59]
    buffer_load_dwordx4 v17, s[24:27], s34 offen offset:1024 lds
    buffer_load_dwordx4 v18, s[24:27], s34 offen offset:2048 lds
    ds_read_b128 v[216:219], v33 offset:8704
    v_mfma_f32_16x16x32_bf16 v[60:63], a[32:35], a[204:207], v[60:63]
    buffer_load_dwordx4 v19, s[24:27], s34 offen offset:3072 lds
    ds_read_b128 a[212:215], v3 offset:15360
    ds_read_b128 v[220:223], v33 offset:8960
    v_mfma_f32_16x16x32_bf16 v[64:67], a[32:35], a[208:211], v[64:67]
    ds_read_b128 a[216:219], v3 offset:16384
    ds_read_b128 a[220:223], v3 offset:17408
    ds_read_b128 v[224:227], v33 offset:9216
    v_mfma_f32_16x16x32_bf16 v[68:71], a[36:39], a[192:195], v[68:71]
    ds_read_b128 a[224:227], v3 offset:18432
    ds_read_b128 a[228:231], v3 offset:19456
    s_waitcnt lgkmcnt(9)
    v_add_f32 v208, v208, v209
    v_mfma_f32_16x16x32_bf16 v[72:75], a[36:39], a[196:199], v[72:75]
    s_waitcnt vmcnt(16)
    ds_read_b64_tr_b16 v[128:129], v20 offset:0
    v_add_f32 v210, v210, v211
    v_mfma_f32_16x16x32_bf16 v[76:79], a[36:39], a[200:203], v[76:79]
    ds_read_b64_tr_b16 v[130:131], v20 offset:2048
    ds_read_b64_tr_b16 v[132:133], v21 offset:0
    v_add_f32 v208, v208, v210
    v_mfma_f32_16x16x32_bf16 v[80:83], a[36:39], a[204:207], v[80:83]
    ds_read_b64_tr_b16 v[134:135], v21 offset:2048
    ds_read_b64_tr_b16 v[136:137], v22 offset:0
    v_rcp_f32 v35, v208
    v_mfma_f32_16x16x32_bf16 v[84:87], a[36:39], a[208:211], v[84:87]
    ds_read_b64_tr_b16 v[138:139], v22 offset:2048
    s_waitcnt lgkmcnt(14)
    v_add_f32 v212, v212, v213
    v_add_f32 v214, v214, v215
    v_mfma_f32_16x16x32_bf16 v[88:91], a[40:43], a[192:195], v[88:91]
    v_add_f32 v212, v212, v214
    v_rcp_f32 v36, v212
    s_waitcnt lgkmcnt(13)
    v_add_f32 v216, v216, v217
    v_mfma_f32_16x16x32_bf16 v[92:95], a[40:43], a[196:199], v[92:95]
    v_add_f32 v218, v218, v219
    v_add_f32 v216, v216, v218
    v_rcp_f32 v37, v216
    v_mfma_f32_16x16x32_bf16 v[96:99], a[40:43], a[200:203], v[96:99]
    s_waitcnt lgkmcnt(11)
    v_add_f32 v220, v220, v221
    v_add_f32 v222, v222, v223
    v_add_f32 v220, v220, v222
    v_mfma_f32_16x16x32_bf16 v[100:103], a[40:43], a[204:207], v[100:103]
    v_rcp_f32 v38, v220
    s_waitcnt lgkmcnt(8)
    v_add_f32 v224, v224, v225
    v_add_f32 v226, v226, v227
    v_mfma_f32_16x16x32_bf16 v[104:107], a[40:43], a[208:211], v[104:107]
    v_add_f32 v224, v224, v226
    v_rcp_f32 v39, v224
    v_mfma_f32_16x16x32_bf16 v[108:111], a[44:47], a[192:195], v[108:111]
    v_mfma_f32_16x16x32_bf16 v[112:115], a[44:47], a[196:199], v[112:115]
    v_mfma_f32_16x16x32_bf16 v[116:119], a[44:47], a[200:203], v[116:119]
    v_mfma_f32_16x16x32_bf16 v[120:123], a[44:47], a[204:207], v[120:123]
    v_mfma_f32_16x16x32_bf16 v[124:127], a[44:47], a[208:211], v[124:127]
    s_waitcnt lgkmcnt(6)
    v_mfma_f32_16x16x32_bf16 v[48:51], a[48:51], a[212:215], v[48:51]
    s_waitcnt lgkmcnt(0)
    s_add_u32 m0, s33, 0
    v_mfma_f32_16x16x32_bf16 v[52:55], a[48:51], a[216:219], v[52:55]
    s_add_u32 s34, s36, 143360
    buffer_load_dwordx4 v16, s[24:27], s34 offen offset:0 lds
    v_mfma_f32_16x16x32_bf16 v[56:59], a[48:51], a[220:223], v[56:59]
    buffer_load_dwordx4 v17, s[24:27], s34 offen offset:1024 lds
    buffer_load_dwordx4 v18, s[24:27], s34 offen offset:2048 lds
    v_mfma_f32_16x16x32_bf16 v[60:63], a[48:51], a[224:227], v[60:63]
    buffer_load_dwordx4 v19, s[24:27], s34 offen offset:3072 lds
    ds_read_b128 a[192:195], v3 offset:30720
    v_mfma_f32_16x16x32_bf16 v[64:67], a[48:51], a[228:231], v[64:67]
    ds_read_b128 a[196:199], v3 offset:31744
    ds_read_b128 a[200:203], v3 offset:32768
    v_mfma_f32_16x16x32_bf16 v[68:71], a[52:55], a[212:215], v[68:71]
    ds_read_b128 a[204:207], v3 offset:33792
    ds_read_b128 a[208:211], v3 offset:34816
    v_mfma_f32_16x16x32_bf16 v[72:75], a[52:55], a[216:219], v[72:75]
    s_waitcnt vmcnt(16)
    ds_read_b64_tr_b16 v[140:141], v20 offset:8192
    v_mfma_f32_16x16x32_bf16 v[76:79], a[52:55], a[220:223], v[76:79]
    ds_read_b64_tr_b16 v[142:143], v20 offset:10240
    ds_read_b64_tr_b16 v[144:145], v21 offset:8192
    v_mfma_f32_16x16x32_bf16 v[80:83], a[52:55], a[224:227], v[80:83]
    ds_read_b64_tr_b16 v[146:147], v21 offset:10240
    ds_read_b64_tr_b16 v[148:149], v22 offset:8192
    v_mfma_f32_16x16x32_bf16 v[84:87], a[52:55], a[228:231], v[84:87]
    ds_read_b64_tr_b16 v[150:151], v22 offset:10240
    s_waitcnt vmcnt(12)
    v_mfma_f32_16x16x32_bf16 v[88:91], a[56:59], a[212:215], v[88:91]
    ds_read_b64_tr_b16 v[152:153], v20 offset:4096
    ds_read_b64_tr_b16 v[154:155], v20 offset:6144
    v_mfma_f32_16x16x32_bf16 v[92:95], a[56:59], a[216:219], v[92:95]
    ds_read_b64_tr_b16 v[156:157], v21 offset:4096
    ds_read_b64_tr_b16 v[158:159], v21 offset:6144
    v_mfma_f32_16x16x32_bf16 v[96:99], a[56:59], a[220:223], v[96:99]
    ds_read_b64_tr_b16 v[160:161], v22 offset:4096
    ds_read_b64_tr_b16 v[162:163], v22 offset:6144
    v_mfma_f32_16x16x32_bf16 v[100:103], a[56:59], a[224:227], v[100:103]
    v_mfma_f32_16x16x32_bf16 v[104:107], a[56:59], a[228:231], v[104:107]
    v_mfma_f32_16x16x32_bf16 v[108:111], a[60:63], a[212:215], v[108:111]
    v_mfma_f32_16x16x32_bf16 v[112:115], a[60:63], a[216:219], v[112:115]
    v_mfma_f32_16x16x32_bf16 v[116:119], a[60:63], a[220:223], v[116:119]
    v_mfma_f32_16x16x32_bf16 v[120:123], a[60:63], a[224:227], v[120:123]
    v_mfma_f32_16x16x32_bf16 v[124:127], a[60:63], a[228:231], v[124:127]
    s_waitcnt lgkmcnt(12)
    v_mfma_f32_16x16x32_bf16 v[48:51], a[64:67], a[192:195], v[48:51]
    s_waitcnt lgkmcnt(0)
    s_add_u32 m0, s33, 4096
    v_mfma_f32_16x16x32_bf16 v[52:55], a[64:67], a[196:199], v[52:55]
    s_add_u32 s34, s36, 172032
    buffer_load_dwordx4 v16, s[24:27], s34 offen offset:0 lds
    v_mfma_f32_16x16x32_bf16 v[56:59], a[64:67], a[200:203], v[56:59]
    buffer_load_dwordx4 v17, s[24:27], s34 offen offset:1024 lds
    buffer_load_dwordx4 v18, s[24:27], s34 offen offset:2048 lds
    v_mfma_f32_16x16x32_bf16 v[60:63], a[64:67], a[204:207], v[60:63]
    buffer_load_dwordx4 v19, s[24:27], s34 offen offset:3072 lds
    s_add_u32 m0, s33, 8192
    v_mfma_f32_16x16x32_bf16 v[64:67], a[64:67], a[208:211], v[64:67]
    s_add_u32 s34, s36, 200704
    buffer_load_dwordx4 v16, s[24:27], s34 offen offset:0 lds
    v_mfma_f32_16x16x32_bf16 v[68:71], a[68:71], a[192:195], v[68:71]
    buffer_load_dwordx4 v17, s[24:27], s34 offen offset:1024 lds
    buffer_load_dwordx4 v18, s[24:27], s34 offen offset:2048 lds
    v_mfma_f32_16x16x32_bf16 v[72:75], a[68:71], a[196:199], v[72:75]
    buffer_load_dwordx4 v19, s[24:27], s34 offen offset:3072 lds
    ds_read_b128 a[212:215], v3 offset:35840
    v_mfma_f32_16x16x32_bf16 v[76:79], a[68:71], a[200:203], v[76:79]
    ds_read_b128 a[216:219], v3 offset:36864
    ds_read_b128 a[220:223], v3 offset:37888
    v_mfma_f32_16x16x32_bf16 v[80:83], a[68:71], a[204:207], v[80:83]
    ds_read_b128 a[224:227], v3 offset:38912
    ds_read_b128 a[228:231], v3 offset:39936
    v_mfma_f32_16x16x32_bf16 v[84:87], a[68:71], a[208:211], v[84:87]
    s_waitcnt vmcnt(16)
    ds_read_b64_tr_b16 v[164:165], v20 offset:16384
    v_mfma_f32_16x16x32_bf16 v[88:91], a[72:75], a[192:195], v[88:91]
    ds_read_b64_tr_b16 v[166:167], v20 offset:18432
    ds_read_b64_tr_b16 v[168:169], v21 offset:16384
    v_mfma_f32_16x16x32_bf16 v[92:95], a[72:75], a[196:199], v[92:95]
    ds_read_b64_tr_b16 v[170:171], v21 offset:18432
    ds_read_b64_tr_b16 v[172:173], v22 offset:16384
    v_mfma_f32_16x16x32_bf16 v[96:99], a[72:75], a[200:203], v[96:99]
    ds_read_b64_tr_b16 v[174:175], v22 offset:18432
    s_waitcnt vmcnt(12)
    v_mfma_f32_16x16x32_bf16 v[100:103], a[72:75], a[204:207], v[100:103]
    ds_read_b64_tr_b16 v[176:177], v20 offset:12288
    ds_read_b64_tr_b16 v[178:179], v20 offset:14336
    v_mfma_f32_16x16x32_bf16 v[104:107], a[72:75], a[208:211], v[104:107]
    ds_read_b64_tr_b16 v[180:181], v21 offset:12288
    ds_read_b64_tr_b16 v[182:183], v21 offset:14336
    v_mfma_f32_16x16x32_bf16 v[108:111], a[76:79], a[192:195], v[108:111]
    ds_read_b64_tr_b16 v[184:185], v22 offset:12288
    ds_read_b64_tr_b16 v[186:187], v22 offset:14336
    v_mfma_f32_16x16x32_bf16 v[112:115], a[76:79], a[196:199], v[112:115]
    v_mfma_f32_16x16x32_bf16 v[116:119], a[76:79], a[200:203], v[116:119]
    v_mfma_f32_16x16x32_bf16 v[120:123], a[76:79], a[204:207], v[120:123]
    v_mfma_f32_16x16x32_bf16 v[124:127], a[76:79], a[208:211], v[124:127]
    s_waitcnt lgkmcnt(12)
    v_mfma_f32_16x16x32_bf16 v[48:51], a[80:83], a[212:215], v[48:51]
    s_waitcnt lgkmcnt(0)
    s_add_u32 m0, s33, 12288
    s_add_u32 s34, s35, 0
    v_mfma_f32_16x16x32_bf16 v[52:55], a[80:83], a[216:219], v[52:55]
    buffer_load_dwordx4 v12, s[24:27], s34 offen offset:0 lds
    buffer_load_dwordx4 v13, s[24:27], s34 offen offset:1024 lds
    buffer_load_dwordx4 v14, s[24:27], s34 offen offset:2048 lds
    v_mfma_f32_16x16x32_bf16 v[56:59], a[80:83], a[220:223], v[56:59]
    buffer_load_dwordx4 v15, s[24:27], s34 offen offset:3072 lds
    s_add_u32 m0, s33, 16384
    s_add_u32 s34, s35, 28672
    v_mfma_f32_16x16x32_bf16 v[60:63], a[80:83], a[224:227], v[60:63]
    buffer_load_dwordx4 v12, s[24:27], s34 offen offset:0 lds
    buffer_load_dwordx4 v13, s[24:27], s34 offen offset:1024 lds
    buffer_load_dwordx4 v14, s[24:27], s34 offen offset:2048 lds
    v_mfma_f32_16x16x32_bf16 v[64:67], a[80:83], a[228:231], v[64:67]
    buffer_load_dwordx4 v15, s[24:27], s34 offen offset:3072 lds
    s_waitcnt vmcnt(16)
    ds_read_b64_tr_b16 v[188:189], v20 offset:0
    v_mfma_f32_16x16x32_bf16 v[68:71], a[84:87], a[212:215], v[68:71]
    ds_read_b64_tr_b16 v[190:191], v20 offset:2048
    ds_read_b64_tr_b16 v[192:193], v21 offset:0
    ds_read_b64_tr_b16 v[194:195], v21 offset:2048
    v_mfma_f32_16x16x32_bf16 v[72:75], a[84:87], a[216:219], v[72:75]
    ds_read_b64_tr_b16 v[196:197], v22 offset:0
    ds_read_b64_tr_b16 v[198:199], v22 offset:2048
    s_waitcnt vmcnt(12)
    v_mfma_f32_16x16x32_bf16 v[76:79], a[84:87], a[220:223], v[76:79]
    ds_read_b64_tr_b16 a[232:233], v20 offset:4096
    ds_read_b64_tr_b16 a[234:235], v20 offset:6144
    ds_read_b64_tr_b16 a[236:237], v21 offset:4096
    v_mfma_f32_16x16x32_bf16 v[80:83], a[84:87], a[224:227], v[80:83]
    ds_read_b64_tr_b16 a[238:239], v21 offset:6144
    ds_read_b64_tr_b16 a[240:241], v22 offset:4096
    ds_read_b64_tr_b16 a[242:243], v22 offset:6144
    v_mfma_f32_16x16x32_bf16 v[84:87], a[84:87], a[228:231], v[84:87]
    v_mfma_f32_16x16x32_bf16 v[88:91], a[88:91], a[212:215], v[88:91]
    v_mul_f32 v48, v35, v48
    v_mul_f32 v49, v35, v49
    v_mul_f32 v50, v35, v50
    v_mfma_f32_16x16x32_bf16 v[92:95], a[88:91], a[216:219], v[92:95]
    v_mul_f32 v51, v35, v51
    v_cvt_pk_bf16_f32 v228, v48, v49
    v_cvt_pk_bf16_f32 v229, v50, v51
    v_mfma_f32_16x16x32_bf16 v[96:99], a[88:91], a[220:223], v[96:99]
    v_mul_f32 v52, v36, v52
    v_mul_f32 v53, v36, v53
    v_mul_f32 v54, v36, v54
    v_mfma_f32_16x16x32_bf16 v[100:103], a[88:91], a[224:227], v[100:103]
    v_mul_f32 v55, v36, v55
    v_cvt_pk_bf16_f32 v232, v52, v53
    v_cvt_pk_bf16_f32 v233, v54, v55
    v_mfma_f32_16x16x32_bf16 v[104:107], a[88:91], a[228:231], v[104:107]
    v_mul_f32 v56, v37, v56
    v_mul_f32 v57, v37, v57
    v_mul_f32 v58, v37, v58
    v_mfma_f32_16x16x32_bf16 v[108:111], a[92:95], a[212:215], v[108:111]
    v_mul_f32 v59, v37, v59
    v_cvt_pk_bf16_f32 v236, v56, v57
    v_cvt_pk_bf16_f32 v237, v58, v59
    v_mfma_f32_16x16x32_bf16 v[112:115], a[92:95], a[216:219], v[112:115]
    v_mul_f32 v60, v38, v60
    v_mul_f32 v61, v38, v61
    v_mul_f32 v62, v38, v62
    v_mfma_f32_16x16x32_bf16 v[116:119], a[92:95], a[220:223], v[116:119]
    v_mul_f32 v63, v38, v63
    v_cvt_pk_bf16_f32 v240, v60, v61
    v_cvt_pk_bf16_f32 v241, v62, v63
    v_mfma_f32_16x16x32_bf16 v[120:123], a[92:95], a[224:227], v[120:123]
    v_mul_f32 v64, v39, v64
    v_mul_f32 v65, v39, v65
    v_mul_f32 v66, v39, v66
    v_mfma_f32_16x16x32_bf16 v[124:127], a[92:95], a[228:231], v[124:127]
    v_mul_f32 v67, v39, v67
    v_cvt_pk_bf16_f32 v244, v64, v65
    v_cvt_pk_bf16_f32 v245, v66, v67
    v_mul_f32 v68, v35, v68
    v_mul_f32 v69, v35, v69
    v_mul_f32 v70, v35, v70
    v_mul_f32 v71, v35, v71
    v_cvt_pk_bf16_f32 v230, v68, v69
    v_cvt_pk_bf16_f32 v231, v70, v71
    v_mul_f32 v72, v36, v72
    v_mul_f32 v73, v36, v73
    v_mul_f32 v74, v36, v74
    v_mul_f32 v75, v36, v75
    ds_write_b128 v31, v[228:231] offset:0
    v_cvt_pk_bf16_f32 v234, v72, v73
    v_cvt_pk_bf16_f32 v235, v74, v75
    v_mul_f32 v76, v37, v76
    v_mul_f32 v77, v37, v77
    v_mul_f32 v78, v37, v78
    v_mul_f32 v79, v37, v79
    ds_write_b128 v31, v[232:235] offset:1024
    v_cvt_pk_bf16_f32 v238, v76, v77
    v_cvt_pk_bf16_f32 v239, v78, v79
    v_mul_f32 v80, v38, v80
    v_mul_f32 v81, v38, v81
    v_mul_f32 v82, v38, v82
    v_mul_f32 v83, v38, v83
    ds_write_b128 v31, v[236:239] offset:2048
    v_cvt_pk_bf16_f32 v242, v80, v81
    v_cvt_pk_bf16_f32 v243, v82, v83
    v_mul_f32 v84, v39, v84
    v_mul_f32 v85, v39, v85
    v_mul_f32 v86, v39, v86
    v_mul_f32 v87, v39, v87
    ds_write_b128 v31, v[240:243] offset:3072
    v_cvt_pk_bf16_f32 v246, v84, v85
    v_cvt_pk_bf16_f32 v247, v86, v87
    v_mul_f32 v88, v35, v88
    v_mul_f32 v89, v35, v89
    v_mul_f32 v90, v35, v90
    v_mul_f32 v91, v35, v91
    ds_write_b128 v31, v[244:247] offset:4096
    v_cvt_pk_bf16_f32 v228, v88, v89
    v_cvt_pk_bf16_f32 v229, v90, v91
    v_mul_f32 v92, v36, v92
    v_mul_f32 v93, v36, v93
    v_mul_f32 v94, v36, v94
    v_mul_f32 v95, v36, v95
    v_cvt_pk_bf16_f32 v232, v92, v93
    v_cvt_pk_bf16_f32 v233, v94, v95
    v_mul_f32 v96, v37, v96
    v_mul_f32 v97, v37, v97
    v_mul_f32 v98, v37, v98
    v_mul_f32 v99, v37, v99
    v_cvt_pk_bf16_f32 v236, v96, v97
    v_cvt_pk_bf16_f32 v237, v98, v99
    v_mul_f32 v100, v38, v100
    v_mul_f32 v101, v38, v101
    v_mul_f32 v102, v38, v102
    v_mul_f32 v103, v38, v103
    v_cvt_pk_bf16_f32 v240, v100, v101
    v_cvt_pk_bf16_f32 v241, v102, v103
    v_mul_f32 v104, v39, v104
    v_mul_f32 v105, v39, v105
    v_mul_f32 v106, v39, v106
    v_mul_f32 v107, v39, v107
    v_cvt_pk_bf16_f32 v244, v104, v105
    v_cvt_pk_bf16_f32 v245, v106, v107
    v_mul_f32 v108, v35, v108
    v_mul_f32 v109, v35, v109
    v_mul_f32 v110, v35, v110
    v_mul_f32 v111, v35, v111
    v_cvt_pk_bf16_f32 v230, v108, v109
    v_cvt_pk_bf16_f32 v231, v110, v111
    v_mul_f32 v112, v36, v112
    v_mul_f32 v113, v36, v113
    v_mul_f32 v114, v36, v114
    v_mul_f32 v115, v36, v115
    ds_write_b128 v31, v[228:231] offset:5120
    v_cvt_pk_bf16_f32 v234, v112, v113
    v_cvt_pk_bf16_f32 v235, v114, v115
    v_mul_f32 v116, v37, v116
    v_mul_f32 v117, v37, v117
    v_mul_f32 v118, v37, v118
    v_mul_f32 v119, v37, v119
    ds_write_b128 v31, v[232:235] offset:6144
    v_cvt_pk_bf16_f32 v238, v116, v117
    v_cvt_pk_bf16_f32 v239, v118, v119
    v_mul_f32 v120, v38, v120
    v_mul_f32 v121, v38, v121
    v_mul_f32 v122, v38, v122
    v_mul_f32 v123, v38, v123
    ds_write_b128 v31, v[236:239] offset:7168
    v_cvt_pk_bf16_f32 v242, v120, v121
    v_cvt_pk_bf16_f32 v243, v122, v123
    v_mul_f32 v124, v39, v124
    v_mul_f32 v125, v39, v125
    v_mul_f32 v126, v39, v126
    v_mul_f32 v127, v39, v127
    ds_write_b128 v31, v[240:243] offset:8192
    v_cvt_pk_bf16_f32 v246, v124, v125
    v_cvt_pk_bf16_f32 v247, v126, v127
    ds_write_b128 v31, v[244:247] offset:9216
    s_waitcnt lgkmcnt(0)
    s_barrier
    ds_read_b128 a[0:3], v1 offset:0
    ds_read_b128 a[4:7], v1 offset:1024
    ds_read_b128 a[8:11], v1 offset:2048
    ds_read_b128 a[12:15], v1 offset:3072
    ds_read_b128 a[16:19], v1 offset:4096
    ds_read_b128 a[20:23], v1 offset:5120
    ds_read_b128 a[24:27], v1 offset:6144
    ds_read_b128 a[28:31], v1 offset:7168
    ds_read_b128 a[32:35], v1 offset:8192
    ds_read_b128 a[36:39], v1 offset:9216
    s_add_u32 m0, s43, 10240
    s_add_u32 s34, s35, 57344
    buffer_load_dwordx4 v12, s[24:27], s34 offen offset:0 lds
    buffer_load_dwordx4 v13, s[24:27], s34 offen offset:1024 lds
    buffer_load_dwordx4 v14, s[24:27], s34 offen offset:2048 lds
    buffer_load_dwordx4 v15, s[24:27], s34 offen offset:3072 lds
    s_add_u32 m0, s43, 14336
    s_add_u32 s34, s35, 86016
    buffer_load_dwordx4 v12, s[24:27], s34 offen offset:0 lds
    buffer_load_dwordx4 v13, s[24:27], s34 offen offset:1024 lds
    buffer_load_dwordx4 v14, s[24:27], s34 offen offset:2048 lds
    buffer_load_dwordx4 v15, s[24:27], s34 offen offset:3072 lds
    s_waitcnt vmcnt(16)
    ds_read_b64_tr_b16 a[244:245], v20 offset:8192
    ds_read_b64_tr_b16 a[246:247], v20 offset:10240
    ds_read_b64_tr_b16 a[248:249], v21 offset:8192
    ds_read_b64_tr_b16 a[250:251], v21 offset:10240
    ds_read_b64_tr_b16 a[252:253], v22 offset:8192
    ds_read_b64_tr_b16 a[254:255], v22 offset:10240
    ds_read_b128 a[40:43], v1 offset:20480
    ds_read_b128 a[44:47], v1 offset:21504
    ds_read_b128 a[48:51], v1 offset:22528
    ds_read_b128 a[52:55], v1 offset:23552
    ds_read_b128 a[56:59], v1 offset:24576
    ds_read_b128 a[60:63], v1 offset:25600
    ds_read_b128 a[64:67], v1 offset:26624
    ds_read_b128 a[68:71], v1 offset:27648
    ds_read_b128 a[72:75], v1 offset:28672
    ds_read_b128 a[76:79], v1 offset:29696
    s_mov_b32 s39, 0
L_tagA:
    v_readfirstlane_b32 s98, v254
    v_readfirstlane_b32 s99, v255
    s_nop 0
    s_cmp_lg_u32 s98, 0
    s_cbranch_scc1 L_tagokA
    s_add_u32 s39, s39, 1
    s_cmp_gt_u32 s39, 0x40000
    s_cbranch_scc1 L_tagokA
    s_sleep 8
    v_mov_b32 v47, 0
    buffer_load_dwordx2 v[254:255], v47, s[80:83], 0 offen sc0 sc1
    s_waitcnt vmcnt(0)
    s_branch L_tagA
L_tagokA:
    s_lshl_b32 s96, s41, 3
    v_lshlrev_b32 v47, 12, v0
    s_waitcnt lgkmcnt(15)
    v_mfma_f32_16x16x32_bf16 v[48:51], v[128:131], a[0:3], 0
    ds_read_b128 a[80:83], v2 offset:0
    ds_read_b128 a[84:87], v2 offset:1024
    v_mfma_f32_16x16x32_bf16 v[52:55], v[128:131], a[4:7], 0
    ds_read_b128 a[88:91], v2 offset:2048
    ds_read_b128 a[92:95], v2 offset:3072
    v_mfma_f32_16x16x32_bf16 v[56:59], v[128:131], a[8:11], 0
    ds_read_b128 a[96:99], v2 offset:4096
    ds_read_b128 a[100:103], v2 offset:5120
    v_mfma_f32_16x16x32_bf16 v[60:63], v[128:131], a[12:15], 0
    ds_read_b128 a[104:107], v2 offset:6144
    ds_read_b128 a[108:111], v2 offset:7168
    v_mfma_f32_16x16x32_bf16 v[64:67], v[128:131], a[16:19], 0
    ds_read_b128 a[112:115], v2 offset:8192
    ds_read_b128 a[116:119], v2 offset:9216
    v_mfma_f32_16x16x32_bf16 v[48:51], v[140:143], a[20:23], v[48:51]
    ds_read_b128 a[120:123], v2 offset:20480
    ds_read_b128 a[124:127], v2 offset:21504
    v_mfma_f32_16x16x32_bf16 v[52:55], v[140:143], a[24:27], v[52:55]
    ds_read_b128 a[128:131], v2 offset:22528
    ds_read_b128 a[132:135], v2 offset:23552
    v_mfma_f32_16x16x32_bf16 v[56:59], v[140:143], a[28:31], v[56:59]
    ds_read_b128 a[136:139], v2 offset:24576
    ds_read_b128 a[140:143], v2 offset:25600
    v_mfma_f32_16x16x32_bf16 v[60:63], v[140:143], a[32:35], v[60:63]
    ds_read_b128 a[144:147], v2 offset:26624
    ds_read_b128 a[148:151], v2 offset:27648
    v_mfma_f32_16x16x32_bf16 v[64:67], v[140:143], a[36:39], v[64:67]
    ds_read_b128 a[152:155], v2 offset:28672
    ds_read_b128 a[156:159], v2 offset:29696
    s_waitcnt lgkmcnt(15)
    v_mfma_f32_16x16x32_bf16 v[48:51], v[152:155], a[40:43], v[48:51]
    s_add_u32 m0, s33, 0
    v_mfma_f32_16x16x32_bf16 v[52:55], v[152:155], a[44:47], v[52:55]
    s_add_u32 s34, s35, 114688
    buffer_load_dwordx4 v12, s[24:27], s34 offen offset:0 lds
    v_mfma_f32_16x16x32_bf16 v[56:59], v[152:155], a[48:51], v[56:59]
    buffer_load_dwordx4 v13, s[24:27], s34 offen offset:1024 lds
    buffer_load_dwordx4 v14, s[24:27], s34 offen offset:2048 lds
    v_mfma_f32_16x16x32_bf16 v[60:63], v[152:155], a[52:55], v[60:63]
    buffer_load_dwordx4 v15, s[24:27], s34 offen offset:3072 lds
    s_add_u32 m0, s33, 4096
    v_mfma_f32_16x16x32_bf16 v[64:67], v[152:155], a[56:59], v[64:67]
    s_add_u32 s34, s35, 143360
    buffer_load_dwordx4 v12, s[24:27], s34 offen offset:0 lds
    v_mfma_f32_16x16x32_bf16 v[48:51], v[164:167], a[60:63], v[48:51]
    buffer_load_dwordx4 v13, s[24:27], s34 offen offset:1024 lds
    buffer_load_dwordx4 v14, s[24:27], s34 offen offset:2048 lds
    v_mfma_f32_16x16x32_bf16 v[52:55], v[164:167], a[64:67], v[52:55]
    buffer_load_dwordx4 v15, s[24:27], s34 offen offset:3072 lds
    v_mfma_f32_16x16x32_bf16 v[56:59], v[164:167], a[68:71], v[56:59]
    v_mfma_f32_16x16x32_bf16 v[60:63], v[164:167], a[72:75], v[60:63]
    v_mfma_f32_16x16x32_bf16 v[64:67], v[164:167], a[76:79], v[64:67]
    s_waitcnt lgkmcnt(0)
    v_mfma_f32_16x16x32_bf16 v[48:51], v[176:179], a[80:83], v[48:51]
    s_add_u32 m0, s33, 8192
    s_add_u32 s34, s35, 172032
    buffer_load_dwordx4 v12, s[24:27], s34 offen offset:0 lds
    v_mfma_f32_16x16x32_bf16 v[52:55], v[176:179], a[84:87], v[52:55]
    buffer_load_dwordx4 v13, s[24:27], s34 offen offset:1024 lds
    buffer_load_dwordx4 v14, s[24:27], s34 offen offset:2048 lds
    buffer_load_dwordx4 v15, s[24:27], s34 offen offset:3072 lds
    v_mfma_f32_16x16x32_bf16 v[56:59], v[176:179], a[88:91], v[56:59]
    s_waitcnt vmcnt(24)
    ds_read_b64_tr_b16 a[160:161], v20 offset:12288
    ds_read_b64_tr_b16 a[162:163], v20 offset:14336
    v_mfma_f32_16x16x32_bf16 v[60:63], v[176:179], a[92:95], v[60:63]
    ds_read_b64_tr_b16 a[164:165], v21 offset:12288
    ds_read_b64_tr_b16 a[166:167], v21 offset:14336
    ds_read_b64_tr_b16 a[168:169], v22 offset:12288
    v_mfma_f32_16x16x32_bf16 v[64:67], v[176:179], a[96:99], v[64:67]
    ds_read_b64_tr_b16 a[170:171], v22 offset:14336
    ds_read_b64_tr_b16 a[172:173], v23 offset:12288
    ds_read_b64_tr_b16 a[174:175], v23 offset:14336
    v_mfma_f32_16x16x32_bf16 v[48:51], v[188:191], a[100:103], v[48:51]
    v_and_b32 v206, 15, v0
    v_lshlrev_b32 v206, 3, v206
    s_lshl_b32 s3, s41, 31
    v_mfma_f32_16x16x32_bf16 v[52:55], v[188:191], a[104:107], v[52:55]
    s_and_b32 s3, s3, 0xfff
    v_add_u32 v206, s3, v206
    s_lshl_b32 s38, s32, 2
    v_mfma_f32_16x16x32_bf16 v[56:59], v[188:191], a[108:111], v[56:59]
    s_sub_u32 s38, s38, 3
    s_mul_i32 s39, s32, 3
    s_add_u32 s39, s39, 16
    v_mfma_f32_16x16x32_bf16 v[60:63], v[188:191], a[112:115], v[60:63]
    s_mul_i32 s3, s41, 40
    v_min_u32 v212, 39, v0
    v_add_u32 v212, s3, v212
    v_mfma_f32_16x16x32_bf16 v[64:67], v[188:191], a[116:119], v[64:67]
    v_lshlrev_b32 v204, 4, v212
    v_and_b32 v214, 63, v212
    v_lshrrev_b32 v213, 6, v212
    v_mfma_f32_16x16x32_bf16 v[48:51], a[232:235], a[120:123], v[48:51]
    v_lshlrev_b32 v213, 1, v213
    v_mul_u32_u24 v248, 52429, v213
    v_lshrrev_b32 v248, 18, v248
    v_mfma_f32_16x16x32_bf16 v[52:55], a[232:235], a[124:127], v[52:55]
    v_mul_u32_u24 v249, 5, v248
    v_sub_u32 v249, v213, v249
    v_mov_b32 v250, s38
    v_mfma_f32_16x16x32_bf16 v[56:59], a[232:235], a[128:131], v[56:59]
    v_mov_b32 v251, s39
    v_cmp_gt_u32 vcc, 3, v248
    s_nop 1
    v_cndmask_b32 v250, v250, v251, vcc
    v_mfma_f32_16x16x32_bf16 v[60:63], a[232:235], a[132:135], v[60:63]
    v_add_u32 v248, v248, v250
    v_and_b32 v250, 15, v214
    v_mfma_f32_16x16x32_bf16 v[64:67], a[232:235], a[136:139], v[64:67]
    v_mfma_f32_16x16x32_bf16 v[48:51], a[244:247], a[140:143], v[48:51]
    v_mfma_f32_16x16x32_bf16 v[52:55], a[244:247], a[144:147], v[52:55]
    v_mfma_f32_16x16x32_bf16 v[56:59], a[244:247], a[148:151], v[56:59]
    v_mfma_f32_16x16x32_bf16 v[60:63], a[244:247], a[152:155], v[60:63]
    v_mfma_f32_16x16x32_bf16 v[64:67], a[244:247], a[156:159], v[64:67]
    v_mfma_f32_16x16x32_bf16 v[68:71], v[132:135], a[0:3], 0
    s_waitcnt lgkmcnt(0)
    s_add_u32 m0, s33, 12288
    s_add_u32 s34, s35, 200704
    v_mfma_f32_16x16x32_bf16 v[72:75], v[132:135], a[4:7], 0
    buffer_load_dwordx4 v12, s[24:27], s34 offen offset:0 lds
    buffer_load_dwordx4 v13, s[24:27], s34 offen offset:1024 lds
    buffer_load_dwordx4 v14, s[24:27], s34 offen offset:2048 lds
    v_mfma_f32_16x16x32_bf16 v[76:79], v[132:135], a[8:11], 0
    buffer_load_dwordx4 v15, s[24:27], s34 offen offset:3072 lds
    s_waitcnt vmcnt(24)
    ds_read_b64_tr_b16 a[176:177], v20 offset:16384
    v_mfma_f32_16x16x32_bf16 v[80:83], v[132:135], a[12:15], 0
    ds_read_b64_tr_b16 a[178:179], v20 offset:18432
    ds_read_b64_tr_b16 a[180:181], v21 offset:16384
    ds_read_b64_tr_b16 a[182:183], v21 offset:18432
    v_mfma_f32_16x16x32_bf16 v[84:87], v[132:135], a[16:19], 0
    ds_read_b64_tr_b16 a[184:185], v22 offset:16384
    ds_read_b64_tr_b16 a[186:187], v22 offset:18432
    ds_read_b64_tr_b16 a[188:189], v23 offset:16384
    v_mfma_f32_16x16x32_bf16 v[68:71], v[144:147], a[20:23], v[68:71]
    ds_read_b64_tr_b16 a[190:191], v23 offset:18432
    s_waitcnt vmcnt(20)
    ds_read_b64_tr_b16 a[192:193], v26 offset:10240
    v_mfma_f32_16x16x32_bf16 v[72:75], v[144:147], a[24:27], v[72:75]
    ds_read_b64_tr_b16 a[194:195], v26 offset:12288
    ds_read_b64_tr_b16 a[196:197], v27 offset:10240
    ds_read_b64_tr_b16 a[198:199], v27 offset:12288
    v_mfma_f32_16x16x32_bf16 v[76:79], v[144:147], a[28:31], v[76:79]
    ds_read_b64_tr_b16 a[200:201], v28 offset:10240
    ds_read_b64_tr_b16 a[202:203], v28 offset:12288
    ds_read_b64_tr_b16 a[204:205], v29 offset:10240
    v_mfma_f32_16x16x32_bf16 v[80:83], v[144:147], a[32:35], v[80:83]
    ds_read_b64_tr_b16 a[206:207], v29 offset:12288
    v_cvt_pk_bf16_f32 v228, v48, v49
    v_cvt_pk_bf16_f32 v229, v50, v51
    v_mfma_f32_16x16x32_bf16 v[84:87], v[144:147], a[36:39], v[84:87]
    v_cvt_pk_bf16_f32 v230, v52, v53
    v_cvt_pk_bf16_f32 v231, v54, v55
    s_mov_b32 s97, 0
    v_mfma_f32_16x16x32_bf16 v[68:71], v[156:159], a[40:43], v[68:71]
    buffer_store_dwordx4 v[228:231], v1, s[28:31], s97 offen offset:0 sc1
    v_cvt_pk_bf16_f32 v232, v56, v57
    v_cvt_pk_bf16_f32 v233, v58, v59
    v_mfma_f32_16x16x32_bf16 v[72:75], v[156:159], a[44:47], v[72:75]
    v_cvt_pk_bf16_f32 v234, v60, v61
    v_cvt_pk_bf16_f32 v235, v62, v63
    s_mov_b32 s97, 0
    v_mfma_f32_16x16x32_bf16 v[76:79], v[156:159], a[48:51], v[76:79]
    buffer_store_dwordx4 v[232:235], v1, s[28:31], s97 offen offset:1024 sc1
    v_cvt_pk_bf16_f32 v236, v64, v65
    v_cvt_pk_bf16_f32 v237, v66, v67
    v_mfma_f32_16x16x32_bf16 v[80:83], v[156:159], a[52:55], v[80:83]
    v_mfma_f32_16x16x32_bf16 v[84:87], v[156:159], a[56:59], v[84:87]
    v_mfma_f32_16x16x32_bf16 v[68:71], v[168:171], a[60:63], v[68:71]
    v_mfma_f32_16x16x32_bf16 v[72:75], v[168:171], a[64:67], v[72:75]
    v_mfma_f32_16x16x32_bf16 v[76:79], v[168:171], a[68:71], v[76:79]
    v_mfma_f32_16x16x32_bf16 v[80:83], v[168:171], a[72:75], v[80:83]
    v_mfma_f32_16x16x32_bf16 v[84:87], v[168:171], a[76:79], v[84:87]
    v_mfma_f32_16x16x32_bf16 v[68:71], v[180:183], a[80:83], v[68:71]
    s_waitcnt lgkmcnt(0)
    s_waitcnt vmcnt(18)
    ds_read_b64_tr_b16 a[208:209], v26 offset:14336
    v_mfma_f32_16x16x32_bf16 v[72:75], v[180:183], a[84:87], v[72:75]
    ds_read_b64_tr_b16 a[210:211], v26 offset:16384
    ds_read_b64_tr_b16 a[212:213], v27 offset:14336
    ds_read_b64_tr_b16 a[214:215], v27 offset:16384
    v_mfma_f32_16x16x32_bf16 v[76:79], v[180:183], a[88:91], v[76:79]
    ds_read_b64_tr_b16 a[216:217], v28 offset:14336
    ds_read_b64_tr_b16 a[218:219], v28 offset:16384
    ds_read_b64_tr_b16 a[220:221], v29 offset:14336
    v_mfma_f32_16x16x32_bf16 v[80:83], v[180:183], a[92:95], v[80:83]
    ds_read_b64_tr_b16 a[222:223], v29 offset:16384
    s_waitcnt vmcnt(14)
    ds_read_b64_tr_b16 v[88:89], v20 offset:0
    v_mfma_f32_16x16x32_bf16 v[84:87], v[180:183], a[96:99], v[84:87]
    ds_read_b64_tr_b16 v[90:91], v20 offset:2048
    ds_read_b64_tr_b16 v[92:93], v21 offset:0
    ds_read_b64_tr_b16 v[94:95], v21 offset:2048
    v_mfma_f32_16x16x32_bf16 v[68:71], v[192:195], a[100:103], v[68:71]
    ds_read_b64_tr_b16 v[96:97], v22 offset:0
    ds_read_b64_tr_b16 v[98:99], v22 offset:2048
    ds_read_b64_tr_b16 v[100:101], v23 offset:0
    v_mfma_f32_16x16x32_bf16 v[72:75], v[192:195], a[104:107], v[72:75]
    ds_read_b64_tr_b16 v[102:103], v23 offset:2048
    v_lshl_add_u32 v249, v249, 4, v250
    v_mul_u32_u24 v249, 896, v249
    v_mfma_f32_16x16x32_bf16 v[76:79], v[192:195], a[108:111], v[76:79]
    v_lshl_add_u32 v249, v248, 5, v249
    v_lshrrev_b32 v250, 4, v214
    v_lshl_add_u32 v249, v250, 3, v249
    v_mfma_f32_16x16x32_bf16 v[80:83], v[192:195], a[112:115], v[80:83]
    v_mov_b32 v251, 0x7fff0000
    v_cmp_gt_u32 vcc, 40, v0
    s_nop 1
    v_cndmask_b32 v207, v251, v249, vcc
    v_mfma_f32_16x16x32_bf16 v[84:87], v[192:195], a[116:119], v[84:87]
    v_add_u32 v213, 1, v213
    v_mul_u32_u24 v248, 52429, v213
    v_lshrrev_b32 v248, 18, v248
    v_mfma_f32_16x16x32_bf16 v[68:71], a[236:239], a[120:123], v[68:71]
    v_mul_u32_u24 v249, 5, v248
    v_sub_u32 v249, v213, v249
    v_mov_b32 v250, s38
    v_mfma_f32_16x16x32_bf16 v[72:75], a[236:239], a[124:127], v[72:75]
    v_mov_b32 v251, s39
    v_cmp_gt_u32 vcc, 3, v248
    s_nop 1
    v_cndmask_b32 v250, v250, v251, vcc
    v_mfma_f32_16x16x32_bf16 v[76:79], a[236:239], a[128:131], v[76:79]
    v_add_u32 v248, v248, v250
    v_and_b32 v250, 15, v214
    v_lshl_add_u32 v249, v249, 4, v250
    v_mfma_f32_16x16x32_bf16 v[80:83], a[236:239], a[132:135], v[80:83]
    v_mul_u32_u24 v249, 896, v249
    v_lshl_add_u32 v249, v248, 5, v249
    v_lshrrev_b32 v250, 4, v214
    v_mfma_f32_16x16x32_bf16 v[84:87], a[236:239], a[136:139], v[84:87]
    v_lshl_add_u32 v249, v250, 3, v249
    v_mov_b32 v251, 0x7fff0000
    v_cmp_gt_u32 vcc, 40, v0
    v_mfma_f32_16x16x32_bf16 v[68:71], a[248:251], a[140:143], v[68:71]
    v_mfma_f32_16x16x32_bf16 v[72:75], a[248:251], a[144:147], v[72:75]
    v_mfma_f32_16x16x32_bf16 v[76:79], a[248:251], a[148:151], v[76:79]
    v_mfma_f32_16x16x32_bf16 v[80:83], a[248:251], a[152:155], v[80:83]
    v_mfma_f32_16x16x32_bf16 v[84:87], a[248:251], a[156:159], v[84:87]
    v_mfma_f32_16x16x32_bf16 v[48:51], v[136:139], a[0:3], 0
    s_waitcnt lgkmcnt(0)
    s_waitcnt vmcnt(10)
    v_mfma_f32_16x16x32_bf16 v[52:55], v[136:139], a[4:7], 0
    ds_read_b64_tr_b16 v[104:105], v20 offset:4096
    ds_read_b64_tr_b16 v[106:107], v20 offset:6144
    v_mfma_f32_16x16x32_bf16 v[56:59], v[136:139], a[8:11], 0
    ds_read_b64_tr_b16 v[108:109], v21 offset:4096
    ds_read_b64_tr_b16 v[110:111], v21 offset:6144
    v_mfma_f32_16x16x32_bf16 v[60:63], v[136:139], a[12:15], 0
    ds_read_b64_tr_b16 v[112:113], v22 offset:4096
    ds_read_b64_tr_b16 v[114:115], v22 offset:6144
    v_mfma_f32_16x16x32_bf16 v[64:67], v[136:139], a[16:19], 0
    ds_read_b64_tr_b16 v[116:117], v23 offset:4096
    ds_read_b64_tr_b16 v[118:119], v23 offset:6144
    v_mfma_f32_16x16x32_bf16 v[48:51], v[148:151], a[20:23], v[48:51]
    v_cvt_pk_bf16_f32 v238, v68, v69
    v_cvt_pk_bf16_f32 v239, v70, v71
    v_mfma_f32_16x16x32_bf16 v[52:55], v[148:151], a[24:27], v[52:55]
    s_mov_b32 s97, 0
    buffer_store_dwordx4 v[236:239], v1, s[28:31], s97 offen offset:2048 sc1
    v_mfma_f32_16x16x32_bf16 v[56:59], v[148:151], a[28:31], v[56:59]
    v_cvt_pk_bf16_f32 v240, v72, v73
    v_cvt_pk_bf16_f32 v241, v74, v75
    v_mfma_f32_16x16x32_bf16 v[60:63], v[148:151], a[32:35], v[60:63]
    v_cvt_pk_bf16_f32 v242, v76, v77
    v_cvt_pk_bf16_f32 v243, v78, v79
    v_mfma_f32_16x16x32_bf16 v[64:67], v[148:151], a[36:39], v[64:67]
    s_mov_b32 s97, 0
    buffer_store_dwordx4 v[240:243], v1, s[28:31], s97 offen offset:3072 sc1
    v_mfma_f32_16x16x32_bf16 v[48:51], v[160:163], a[40:43], v[48:51]
    v_cvt_pk_bf16_f32 v244, v80, v81
    v_cvt_pk_bf16_f32 v245, v82, v83
    v_mfma_f32_16x16x32_bf16 v[52:55], v[160:163], a[44:47], v[52:55]
    v_cvt_pk_bf16_f32 v246, v84, v85
    v_cvt_pk_bf16_f32 v247, v86, v87
    v_mfma_f32_16x16x32_bf16 v[56:59], v[160:163], a[48:51], v[56:59]
    s_mov_b32 s97, 4096
    buffer_store_dwordx4 v[244:247], v1, s[28:31], s97 offen offset:0 sc1
    v_mfma_f32_16x16x32_bf16 v[60:63], v[160:163], a[52:55], v[60:63]
    v_mfma_f32_16x16x32_bf16 v[64:67], v[160:163], a[56:59], v[64:67]
    v_mfma_f32_16x16x32_bf16 v[48:51], v[172:175], a[60:63], v[48:51]
    v_mfma_f32_16x16x32_bf16 v[52:55], v[172:175], a[64:67], v[52:55]
    v_mfma_f32_16x16x32_bf16 v[56:59], v[172:175], a[68:71], v[56:59]
    v_mfma_f32_16x16x32_bf16 v[60:63], v[172:175], a[72:75], v[60:63]
    v_mfma_f32_16x16x32_bf16 v[64:67], v[172:175], a[76:79], v[64:67]
    v_mfma_f32_16x16x32_bf16 v[48:51], v[184:187], a[80:83], v[48:51]
    s_waitcnt lgkmcnt(0)
    v_cndmask_b32 v208, v251, v249, vcc
    v_mfma_f32_16x16x32_bf16 v[52:55], v[184:187], a[84:87], v[52:55]
    s_lshl_b32 s3, s41, 5
    s_add_u32 s3, s3, 640
    v_mfma_f32_16x16x32_bf16 v[56:59], v[184:187], a[88:91], v[56:59]
    v_and_b32 v212, 31, v0
    v_add_u32 v212, s3, v212
    v_mfma_f32_16x16x32_bf16 v[60:63], v[184:187], a[92:95], v[60:63]
    v_lshrrev_b32 v205, 5, v0
    v_mul_u32_u24 v205, 590848, v205
    v_mfma_f32_16x16x32_bf16 v[64:67], v[184:187], a[96:99], v[64:67]
    v_lshl_add_u32 v205, v212, 4, v205
    v_and_b32 v214, 63, v212
    v_mfma_f32_16x16x32_bf16 v[48:51], v[196:199], a[100:103], v[48:51]
    v_lshrrev_b32 v213, 6, v212
    v_lshlrev_b32 v213, 1, v213
    v_mfma_f32_16x16x32_bf16 v[52:55], v[196:199], a[104:107], v[52:55]
    v_mul_u32_u24 v248, 52429, v213
    v_lshrrev_b32 v248, 18, v248
    v_mfma_f32_16x16x32_bf16 v[56:59], v[196:199], a[108:111], v[56:59]
    v_mul_u32_u24 v249, 5, v248
    v_sub_u32 v249, v213, v249
    v_mfma_f32_16x16x32_bf16 v[60:63], v[196:199], a[112:115], v[60:63]
    v_mov_b32 v250, s38
    v_mov_b32 v251, s39
    v_mfma_f32_16x16x32_bf16 v[64:67], v[196:199], a[116:119], v[64:67]
    v_cmp_gt_u32 vcc, 3, v248
    s_nop 1
    v_cndmask_b32 v250, v250, v251, vcc
    v_mfma_f32_16x16x32_bf16 v[48:51], a[240:243], a[120:123], v[48:51]
    v_add_u32 v248, v248, v250
    v_and_b32 v250, 15, v214
    v_mfma_f32_16x16x32_bf16 v[52:55], a[240:243], a[124:127], v[52:55]
    v_lshl_add_u32 v249, v249, 4, v250
    v_mul_u32_u24 v249, 896, v249
    v_mfma_f32_16x16x32_bf16 v[56:59], a[240:243], a[128:131], v[56:59]
    v_lshl_add_u32 v249, v248, 5, v249
    v_lshrrev_b32 v250, 4, v214
    v_mfma_f32_16x16x32_bf16 v[60:63], a[240:243], a[132:135], v[60:63]
    v_mfma_f32_16x16x32_bf16 v[64:67], a[240:243], a[136:139], v[64:67]
    v_mfma_f32_16x16x32_bf16 v[48:51], a[252:255], a[140:143], v[48:51]
    v_mfma_f32_16x16x32_bf16 v[52:55], a[252:255], a[144:147], v[52:55]
    v_mfma_f32_16x16x32_bf16 v[56:59], a[252:255], a[148:151], v[56:59]
    v_mfma_f32_16x16x32_bf16 v[60:63], a[252:255], a[152:155], v[60:63]
    v_mfma_f32_16x16x32_bf16 v[64:67], a[252:255], a[156:159], v[64:67]
    v_mfma_f32_16x16x32_bf16 v[68:71], a[160:163], a[0:3], 0
    s_waitcnt vmcnt(9)
    ds_read_b64_tr_b16 v[128:129], v20 offset:8192
    v_mfma_f32_16x16x32_bf16 v[72:75], a[160:163], a[4:7], 0
    ds_read_b64_tr_b16 v[130:131], v20 offset:10240
    ds_read_b64_tr_b16 v[132:133], v21 offset:8192
    v_mfma_f32_16x16x32_bf16 v[76:79], a[160:163], a[8:11], 0
    ds_read_b64_tr_b16 v[134:135], v21 offset:10240
    ds_read_b64_tr_b16 v[136:137], v22 offset:8192
    v_mfma_f32_16x16x32_bf16 v[80:83], a[160:163], a[12:15], 0
    ds_read_b64_tr_b16 v[138:139], v22 offset:10240
    ds_read_b64_tr_b16 v[140:141], v23 offset:8192
    v_mfma_f32_16x16x32_bf16 v[84:87], a[160:163], a[16:19], 0
    ds_read_b64_tr_b16 v[142:143], v23 offset:10240
    s_waitcnt vmcnt(5)
    v_mfma_f32_16x16x32_bf16 v[68:71], a[176:179], a[20:23], v[68:71]
    ds_read_b64_tr_b16 v[144:145], v20 offset:12288
    ds_read_b64_tr_b16 v[146:147], v20 offset:14336
    v_mfma_f32_16x16x32_bf16 v[72:75], a[176:179], a[24:27], v[72:75]
    ds_read_b64_tr_b16 v[148:149], v21 offset:12288
    ds_read_b64_tr_b16 v[150:151], v21 offset:14336
    v_mfma_f32_16x16x32_bf16 v[76:79], a[176:179], a[28:31], v[76:79]
    ds_read_b64_tr_b16 v[152:153], v22 offset:12288
    ds_read_b64_tr_b16 v[154:155], v22 offset:14336
    v_mfma_f32_16x16x32_bf16 v[80:83], a[176:179], a[32:35], v[80:83]
    ds_read_b64_tr_b16 v[156:157], v23 offset:12288
    ds_read_b64_tr_b16 v[158:159], v23 offset:14336
    v_mfma_f32_16x16x32_bf16 v[84:87], a[176:179], a[36:39], v[84:87]
    v_cvt_pk_bf16_f32 v228, v48, v49
    v_cvt_pk_bf16_f32 v229, v50, v51
    v_mfma_f32_16x16x32_bf16 v[68:71], a[192:195], a[40:43], v[68:71]
    v_cvt_pk_bf16_f32 v230, v52, v53
    v_cvt_pk_bf16_f32 v231, v54, v55
    v_mfma_f32_16x16x32_bf16 v[72:75], a[192:195], a[44:47], v[72:75]
    s_mov_b32 s97, 4096
    buffer_store_dwordx4 v[228:231], v1, s[28:31], s97 offen offset:1024 sc1
    v_mfma_f32_16x16x32_bf16 v[76:79], a[192:195], a[48:51], v[76:79]
    v_cvt_pk_bf16_f32 v232, v56, v57
    v_cvt_pk_bf16_f32 v233, v58, v59
    v_mfma_f32_16x16x32_bf16 v[80:83], a[192:195], a[52:55], v[80:83]
    v_cvt_pk_bf16_f32 v234, v60, v61
    v_cvt_pk_bf16_f32 v235, v62, v63
    v_mfma_f32_16x16x32_bf16 v[84:87], a[192:195], a[56:59], v[84:87]
    s_mov_b32 s97, 4096
    buffer_store_dwordx4 v[232:235], v1, s[28:31], s97 offen offset:2048 sc1
    v_mfma_f32_16x16x32_bf16 v[68:71], a[208:211], a[60:63], v[68:71]
    v_cvt_pk_bf16_f32 v236, v64, v65
    v_cvt_pk_bf16_f32 v237, v66, v67
    v_mfma_f32_16x16x32_bf16 v[72:75], a[208:211], a[64:67], v[72:75]
    v_mfma_f32_16x16x32_bf16 v[76:79], a[208:211], a[68:71], v[76:79]
    v_mfma_f32_16x16x32_bf16 v[80:83], a[208:211], a[72:75], v[80:83]
    v_mfma_f32_16x16x32_bf16 v[84:87], a[208:211], a[76:79], v[84:87]
    s_waitcnt lgkmcnt(6)
    v_mfma_f32_16x16x32_bf16 v[68:71], v[88:91], a[80:83], v[68:71]
    s_waitcnt lgkmcnt(0)
    v_lshl_add_u32 v249, v250, 3, v249
    v_mfma_f32_16x16x32_bf16 v[72:75], v[88:91], a[84:87], v[72:75]
    v_mov_b32 v251, 0x7fff0000
    v_cmp_gt_u32 vcc, 32, v0
    v_mfma_f32_16x16x32_bf16 v[76:79], v[88:91], a[88:91], v[76:79]
    s_nop 0
    v_cndmask_b32 v209, v251, v249, vcc
    v_add_u32 v213, 1, v213
    v_mfma_f32_16x16x32_bf16 v[80:83], v[88:91], a[92:95], v[80:83]
    v_mul_u32_u24 v248, 52429, v213
    v_lshrrev_b32 v248, 18, v248
    v_mfma_f32_16x16x32_bf16 v[84:87], v[88:91], a[96:99], v[84:87]
    v_mul_u32_u24 v249, 5, v248
    v_sub_u32 v249, v213, v249
    v_mfma_f32_16x16x32_bf16 v[68:71], v[104:107], a[100:103], v[68:71]
    v_mov_b32 v250, s38
    v_mov_b32 v251, s39
    v_mfma_f32_16x16x32_bf16 v[72:75], v[104:107], a[104:107], v[72:75]
    v_cmp_gt_u32 vcc, 3, v248
    s_nop 1
    v_cndmask_b32 v250, v250, v251, vcc
    v_mfma_f32_16x16x32_bf16 v[76:79], v[104:107], a[108:111], v[76:79]
    v_add_u32 v248, v248, v250
    v_and_b32 v250, 15, v214
    v_mfma_f32_16x16x32_bf16 v[80:83], v[104:107], a[112:115], v[80:83]
    v_lshl_add_u32 v249, v249, 4, v250
    v_mul_u32_u24 v249, 896, v249
    v_mfma_f32_16x16x32_bf16 v[84:87], v[104:107], a[116:119], v[84:87]
    v_lshl_add_u32 v249, v248, 5, v249
    v_lshrrev_b32 v250, 4, v214
    v_mfma_f32_16x16x32_bf16 v[68:71], v[128:131], a[120:123], v[68:71]
    v_lshl_add_u32 v249, v250, 3, v249
    v_mov_b32 v251, 0x7fff0000
    v_mfma_f32_16x16x32_bf16 v[72:75], v[128:131], a[124:127], v[72:75]
    v_lshrrev_b32 v250, 5, v0
    v_lshl_add_u32 v250, v250, 6, v213
    v_mfma_f32_16x16x32_bf16 v[76:79], v[128:131], a[128:131], v[76:79]
    v_cmp_gt_u32 vcc, 35, v250
    s_nop 1
    v_cndmask_b32 v210, v251, v249, vcc
    v_mfma_f32_16x16x32_bf16 v[80:83], v[128:131], a[132:135], v[80:83]
    v_mfma_f32_16x16x32_bf16 v[84:87], v[128:131], a[136:139], v[84:87]
    v_mfma_f32_16x16x32_bf16 v[68:71], v[144:147], a[140:143], v[68:71]
    v_mfma_f32_16x16x32_bf16 v[72:75], v[144:147], a[144:147], v[72:75]
    v_mfma_f32_16x16x32_bf16 v[76:79], v[144:147], a[148:151], v[76:79]
    v_mfma_f32_16x16x32_bf16 v[80:83], v[144:147], a[152:155], v[80:83]
    v_mfma_f32_16x16x32_bf16 v[84:87], v[144:147], a[156:159], v[84:87]
    v_mfma_f32_16x16x32_bf16 v[48:51], a[164:167], a[0:3], 0
    v_mfma_f32_16x16x32_bf16 v[52:55], a[164:167], a[4:7], 0
    v_mfma_f32_16x16x32_bf16 v[56:59], a[164:167], a[8:11], 0
    v_mfma_f32_16x16x32_bf16 v[60:63], a[164:167], a[12:15], 0
    v_mfma_f32_16x16x32_bf16 v[64:67], a[164:167], a[16:19], 0
    v_cvt_pk_bf16_f32 v238, v68, v69
    v_cvt_pk_bf16_f32 v239, v70, v71
    v_mfma_f32_16x16x32_bf16 v[48:51], a[180:183], a[20:23], v[48:51]
    s_mov_b32 s97, 4096
    buffer_store_dwordx4 v[236:239], v1, s[28:31], s97 offen offset:3072 sc1
    v_mfma_f32_16x16x32_bf16 v[52:55], a[180:183], a[24:27], v[52:55]
    v_cvt_pk_bf16_f32 v240, v72, v73
    v_cvt_pk_bf16_f32 v241, v74, v75
    v_mfma_f32_16x16x32_bf16 v[56:59], a[180:183], a[28:31], v[56:59]
    v_cvt_pk_bf16_f32 v242, v76, v77
    v_cvt_pk_bf16_f32 v243, v78, v79
    v_mfma_f32_16x16x32_bf16 v[60:63], a[180:183], a[32:35], v[60:63]
    s_mov_b32 s97, 8192
    buffer_store_dwordx4 v[240:243], v1, s[28:31], s97 offen offset:0 sc1
    v_mfma_f32_16x16x32_bf16 v[64:67], a[180:183], a[36:39], v[64:67]
    v_cvt_pk_bf16_f32 v244, v80, v81
    v_cvt_pk_bf16_f32 v245, v82, v83
    v_mfma_f32_16x16x32_bf16 v[48:51], a[196:199], a[40:43], v[48:51]
    v_cvt_pk_bf16_f32 v246, v84, v85
    v_cvt_pk_bf16_f32 v247, v86, v87
    v_mfma_f32_16x16x32_bf16 v[52:55], a[196:199], a[44:47], v[52:55]
    s_mov_b32 s97, 8192
    buffer_store_dwordx4 v[244:247], v1, s[28:31], s97 offen offset:1024 sc1
    v_mfma_f32_16x16x32_bf16 v[56:59], a[196:199], a[48:51], v[56:59]
    v_mfma_f32_16x16x32_bf16 v[60:63], a[196:199], a[52:55], v[60:63]
    v_mfma_f32_16x16x32_bf16 v[64:67], a[196:199], a[56:59], v[64:67]
    v_mfma_f32_16x16x32_bf16 v[48:51], a[212:215], a[60:63], v[48:51]
    v_mfma_f32_16x16x32_bf16 v[52:55], a[212:215], a[64:67], v[52:55]
    v_mfma_f32_16x16x32_bf16 v[56:59], a[212:215], a[68:71], v[56:59]
    v_mfma_f32_16x16x32_bf16 v[60:63], a[212:215], a[72:75], v[60:63]
    v_mfma_f32_16x16x32_bf16 v[64:67], a[212:215], a[76:79], v[64:67]
    v_mfma_f32_16x16x32_bf16 v[48:51], v[92:95], a[80:83], v[48:51]
    v_mfma_f32_16x16x32_bf16 v[52:55], v[92:95], a[84:87], v[52:55]
    v_mfma_f32_16x16x32_bf16 v[56:59], v[92:95], a[88:91], v[56:59]
    v_mfma_f32_16x16x32_bf16 v[60:63], v[92:95], a[92:95], v[60:63]
    v_mfma_f32_16x16x32_bf16 v[64:67], v[92:95], a[96:99], v[64:67]
    v_mfma_f32_16x16x32_bf16 v[48:51], v[108:111], a[100:103], v[48:51]
    v_mfma_f32_16x16x32_bf16 v[52:55], v[108:111], a[104:107], v[52:55]
    v_mfma_f32_16x16x32_bf16 v[56:59], v[108:111], a[108:111], v[56:59]
    v_mfma_f32_16x16x32_bf16 v[60:63], v[108:111], a[112:115], v[60:63]
    v_mfma_f32_16x16x32_bf16 v[64:67], v[108:111], a[116:119], v[64:67]
    v_mfma_f32_16x16x32_bf16 v[48:51], v[132:135], a[120:123], v[48:51]
    v_mfma_f32_16x16x32_bf16 v[52:55], v[132:135], a[124:127], v[52:55]
    v_mfma_f32_16x16x32_bf16 v[56:59], v[132:135], a[128:131], v[56:59]
    v_mfma_f32_16x16x32_bf16 v[60:63], v[132:135], a[132:135], v[60:63]
    v_mfma_f32_16x16x32_bf16 v[64:67], v[132:135], a[136:139], v[64:67]
    v_mfma_f32_16x16x32_bf16 v[48:51], v[148:151], a[140:143], v[48:51]
    v_mfma_f32_16x16x32_bf16 v[52:55], v[148:151], a[144:147], v[52:55]
    v_mfma_f32_16x16x32_bf16 v[56:59], v[148:151], a[148:151], v[56:59]
    v_mfma_f32_16x16x32_bf16 v[60:63], v[148:151], a[152:155], v[60:63]
    v_mfma_f32_16x16x32_bf16 v[64:67], v[148:151], a[156:159], v[64:67]
    v_mfma_f32_16x16x32_bf16 v[68:71], a[168:171], a[0:3], 0
    v_mfma_f32_16x16x32_bf16 v[72:75], a[168:171], a[4:7], 0
    v_mfma_f32_16x16x32_bf16 v[76:79], a[168:171], a[8:11], 0
    v_mfma_f32_16x16x32_bf16 v[80:83], a[168:171], a[12:15], 0
    v_mfma_f32_16x16x32_bf16 v[84:87], a[168:171], a[16:19], 0
    v_cvt_pk_bf16_f32 v228, v48, v49
    v_cvt_pk_bf16_f32 v229, v50, v51
    v_mfma_f32_16x16x32_bf16 v[68:71], a[184:187], a[20:23], v[68:71]
    v_cvt_pk_bf16_f32 v230, v52, v53
    v_cvt_pk_bf16_f32 v231, v54, v55
    v_mfma_f32_16x16x32_bf16 v[72:75], a[184:187], a[24:27], v[72:75]
    s_mov_b32 s97, 8192
    buffer_store_dwordx4 v[228:231], v1, s[28:31], s97 offen offset:2048 sc1
    v_mfma_f32_16x16x32_bf16 v[76:79], a[184:187], a[28:31], v[76:79]
    v_cvt_pk_bf16_f32 v232, v56, v57
    v_cvt_pk_bf16_f32 v233, v58, v59
    v_mfma_f32_16x16x32_bf16 v[80:83], a[184:187], a[32:35], v[80:83]
    v_cvt_pk_bf16_f32 v234, v60, v61
    v_cvt_pk_bf16_f32 v235, v62, v63
    v_mfma_f32_16x16x32_bf16 v[84:87], a[184:187], a[36:39], v[84:87]
    s_mov_b32 s97, 8192
    buffer_store_dwordx4 v[232:235], v1, s[28:31], s97 offen offset:3072 sc1
    v_mfma_f32_16x16x32_bf16 v[68:71], a[200:203], a[40:43], v[68:71]
    v_cvt_pk_bf16_f32 v236, v64, v65
    v_cvt_pk_bf16_f32 v237, v66, v67
    v_mfma_f32_16x16x32_bf16 v[72:75], a[200:203], a[44:47], v[72:75]
    v_mfma_f32_16x16x32_bf16 v[76:79], a[200:203], a[48:51], v[76:79]
    v_mfma_f32_16x16x32_bf16 v[80:83], a[200:203], a[52:55], v[80:83]
    v_mfma_f32_16x16x32_bf16 v[84:87], a[200:203], a[56:59], v[84:87]
    v_mfma_f32_16x16x32_bf16 v[68:71], a[216:219], a[60:63], v[68:71]
    v_mfma_f32_16x16x32_bf16 v[72:75], a[216:219], a[64:67], v[72:75]
    v_mfma_f32_16x16x32_bf16 v[76:79], a[216:219], a[68:71], v[76:79]
    v_mfma_f32_16x16x32_bf16 v[80:83], a[216:219], a[72:75], v[80:83]
    v_mfma_f32_16x16x32_bf16 v[84:87], a[216:219], a[76:79], v[84:87]
    v_mfma_f32_16x16x32_bf16 v[68:71], v[96:99], a[80:83], v[68:71]
    s_waitcnt vmcnt(2)
    buffer_store_dwordx2 v[254:255], v47, s[84:87], s96 offen sc0 sc1
    v_mfma_f32_16x16x32_bf16 v[72:75], v[96:99], a[84:87], v[72:75]
    v_mfma_f32_16x16x32_bf16 v[76:79], v[96:99], a[88:91], v[76:79]
    v_mfma_f32_16x16x32_bf16 v[80:83], v[96:99], a[92:95], v[80:83]
    v_mfma_f32_16x16x32_bf16 v[84:87], v[96:99], a[96:99], v[84:87]
    v_mfma_f32_16x16x32_bf16 v[68:71], v[112:115], a[100:103], v[68:71]
    v_mfma_f32_16x16x32_bf16 v[72:75], v[112:115], a[104:107], v[72:75]
    v_mfma_f32_16x16x32_bf16 v[76:79], v[112:115], a[108:111], v[76:79]
    v_mfma_f32_16x16x32_bf16 v[80:83], v[112:115], a[112:115], v[80:83]
    v_mfma_f32_16x16x32_bf16 v[84:87], v[112:115], a[116:119], v[84:87]
    v_mfma_f32_16x16x32_bf16 v[68:71], v[136:139], a[120:123], v[68:71]
    v_mfma_f32_16x16x32_bf16 v[72:75], v[136:139], a[124:127], v[72:75]
    v_mfma_f32_16x16x32_bf16 v[76:79], v[136:139], a[128:131], v[76:79]
    v_mfma_f32_16x16x32_bf16 v[80:83], v[136:139], a[132:135], v[80:83]
    v_mfma_f32_16x16x32_bf16 v[84:87], v[136:139], a[136:139], v[84:87]
    v_mfma_f32_16x16x32_bf16 v[68:71], v[152:155], a[140:143], v[68:71]
    v_mfma_f32_16x16x32_bf16 v[72:75], v[152:155], a[144:147], v[72:75]
    v_mfma_f32_16x16x32_bf16 v[76:79], v[152:155], a[148:151], v[76:79]
    v_mfma_f32_16x16x32_bf16 v[80:83], v[152:155], a[152:155], v[80:83]
    v_mfma_f32_16x16x32_bf16 v[84:87], v[152:155], a[156:159], v[84:87]
    v_mfma_f32_16x16x32_bf16 v[48:51], a[172:175], a[0:3], 0
    v_mfma_f32_16x16x32_bf16 v[52:55], a[172:175], a[4:7], 0
    v_mfma_f32_16x16x32_bf16 v[56:59], a[172:175], a[8:11], 0
    v_mfma_f32_16x16x32_bf16 v[60:63], a[172:175], a[12:15], 0
    v_mfma_f32_16x16x32_bf16 v[64:67], a[172:175], a[16:19], 0
    v_cvt_pk_bf16_f32 v238, v68, v69
    v_cvt_pk_bf16_f32 v239, v70, v71
    v_mfma_f32_16x16x32_bf16 v[48:51], a[188:191], a[20:23], v[48:51]
    s_mov_b32 s97, 12288
    buffer_store_dwordx4 v[236:239], v1, s[28:31], s97 offen offset:0 sc1
    v_mfma_f32_16x16x32_bf16 v[52:55], a[188:191], a[24:27], v[52:55]
    v_cvt_pk_bf16_f32 v240, v72, v73
    v_cvt_pk_bf16_f32 v241, v74, v75
    v_mfma_f32_16x16x32_bf16 v[56:59], a[188:191], a[28:31], v[56:59]
    v_cvt_pk_bf16_f32 v242, v76, v77
    v_cvt_pk_bf16_f32 v243, v78, v79
    v_mfma_f32_16x16x32_bf16 v[60:63], a[188:191], a[32:35], v[60:63]
    s_mov_b32 s97, 12288
    buffer_store_dwordx4 v[240:243], v1, s[28:31], s97 offen offset:1024 sc1
    v_mfma_f32_16x16x32_bf16 v[64:67], a[188:191], a[36:39], v[64:67]
    v_cvt_pk_bf16_f32 v244, v80, v81
    v_cvt_pk_bf16_f32 v245, v82, v83
    v_mfma_f32_16x16x32_bf16 v[48:51], a[204:207], a[40:43], v[48:51]
    v_cvt_pk_bf16_f32 v246, v84, v85
    v_cvt_pk_bf16_f32 v247, v86, v87
    v_mfma_f32_16x16x32_bf16 v[52:55], a[204:207], a[44:47], v[52:55]
    s_mov_b32 s97, 12288
    buffer_store_dwordx4 v[244:247], v1, s[28:31], s97 offen offset:2048 sc1
    v_mfma_f32_16x16x32_bf16 v[56:59], a[204:207], a[48:51], v[56:59]
    v_mfma_f32_16x16x32_bf16 v[60:63], a[204:207], a[52:55], v[60:63]
    v_mfma_f32_16x16x32_bf16 v[64:67], a[204:207], a[56:59], v[64:67]
    v_mfma_f32_16x16x32_bf16 v[48:51], a[220:223], a[60:63], v[48:51]
    v_mfma_f32_16x16x32_bf16 v[52:55], a[220:223], a[64:67], v[52:55]
    v_mfma_f32_16x16x32_bf16 v[56:59], a[220:223], a[68:71], v[56:59]
    v_mfma_f32_16x16x32_bf16 v[60:63], a[220:223], a[72:75], v[60:63]
    v_mfma_f32_16x16x32_bf16 v[64:67], a[220:223], a[76:79], v[64:67]
    v_mfma_f32_16x16x32_bf16 v[48:51], v[100:103], a[80:83], v[48:51]
    buffer_load_dwordx2 v[40:41], v206, s[84:87], 0 offen sc0 sc1
    v_mfma_f32_16x16x32_bf16 v[48:51], v[116:119], a[100:103], v[48:51]
    v_mfma_f32_16x16x32_bf16 v[48:51], v[140:143], a[120:123], v[48:51]
    v_mfma_f32_16x16x32_bf16 v[48:51], v[156:159], a[140:143], v[48:51]
    v_mfma_f32_16x16x32_bf16 v[52:55], v[100:103], a[84:87], v[52:55]
    v_mfma_f32_16x16x32_bf16 v[52:55], v[116:119], a[104:107], v[52:55]
    v_mfma_f32_16x16x32_bf16 v[52:55], v[140:143], a[124:127], v[52:55]
    v_mfma_f32_16x16x32_bf16 v[52:55], v[156:159], a[144:147], v[52:55]
    v_mfma_f32_16x16x32_bf16 v[56:59], v[100:103], a[88:91], v[56:59]
    v_mfma_f32_16x16x32_bf16 v[56:59], v[116:119], a[108:111], v[56:59]
    v_mfma_f32_16x16x32_bf16 v[56:59], v[140:143], a[128:131], v[56:59]
    v_mfma_f32_16x16x32_bf16 v[56:59], v[156:159], a[148:151], v[56:59]
    v_mfma_f32_16x16x32_bf16 v[60:63], v[100:103], a[92:95], v[60:63]
    v_cvt_pk_bf16_f32 v228, v48, v49
    v_mfma_f32_16x16x32_bf16 v[60:63], v[116:119], a[112:115], v[60:63]
    v_cvt_pk_bf16_f32 v229, v50, v51
    v_mfma_f32_16x16x32_bf16 v[60:63], v[140:143], a[132:135], v[60:63]
    v_cvt_pk_bf16_f32 v230, v52, v53
    v_mfma_f32_16x16x32_bf16 v[60:63], v[156:159], a[152:155], v[60:63]
    v_cvt_pk_bf16_f32 v231, v54, v55
    v_mfma_f32_16x16x32_bf16 v[64:67], v[100:103], a[96:99], v[64:67]
    s_mov_b32 s97, 12288
    v_mfma_f32_16x16x32_bf16 v[64:67], v[116:119], a[116:119], v[64:67]
    buffer_store_dwordx4 v[228:231], v1, s[28:31], s97 offen offset:3072 sc1
    v_mfma_f32_16x16x32_bf16 v[64:67], v[140:143], a[136:139], v[64:67]
    v_mfma_f32_16x16x32_bf16 v[64:67], v[156:159], a[156:159], v[64:67]
    v_cvt_pk_bf16_f32 v232, v56, v57
    v_cvt_pk_bf16_f32 v233, v58, v59
    v_cvt_pk_bf16_f32 v234, v60, v61
    v_cvt_pk_bf16_f32 v235, v62, v63
    s_mov_b32 s97, 16384
    buffer_store_dwordx4 v[232:235], v1, s[28:31], s97 offen offset:0 sc1
    s_nop 1
    v_cvt_pk_bf16_f32 v236, v64, v65
    v_cvt_pk_bf16_f32 v237, v66, v67
    s_mov_b32 s97, 16384
    buffer_store_dwordx4 v[236:239], v1, s[28:31], s97 offen offset:1024 sc1
    s_waitcnt vmcnt(3)
    v_cmp_eq_u64 vcc, s[98:99], v[40:41]
    s_nop 1
    s_cmp_eq_u64 vcc, exec
    s_cbranch_scc1 L_fastA
    s_mov_b32 s39, 0
    buffer_load_dwordx2 v[40:41], v206, s[84:87], 0 offen offset:0 sc0 sc1
    s_waitcnt vmcnt(0)
    buffer_store_dwordx2 v[254:255], v47, s[84:87], s96 offen offset:1024 sc0 sc1
    v_cmp_eq_u64 vcc, s[98:99], v[40:41]
    s_nop 1
    s_cmp_eq_u64 vcc, exec
    s_cbranch_scc1 L_goAA
L_pollAA:
    buffer_load_dwordx2 v[216:217], v206, s[84:87], 0 offen offset:0 sc0 sc1
    s_waitcnt vmcnt(0)
    v_cmp_eq_u64 vcc, s[98:99], v[216:217]
    s_nop 1
    s_cmp_eq_u64 vcc, exec
    s_cbranch_scc1 L_goAA
    s_sleep 1
    s_add_u32 s39, s39, 1
    s_cmp_lt_u32 s39, 0x20000
    s_cbranch_scc1 L_pollAA
L_goAA:
    s_mov_b32 s38, 0
    buffer_load_dwordx4 v[48:51], v204, s[88:91], s38 offen sc1
    s_mov_b32 s38, 73856
    buffer_load_dwordx4 v[52:55], v204, s[88:91], s38 offen sc1
    s_mov_b32 s38, 147712
    buffer_load_dwordx4 v[56:59], v204, s[88:91], s38 offen sc1
    s_mov_b32 s38, 221568
    buffer_load_dwordx4 v[60:63], v204, s[88:91], s38 offen sc1
    s_mov_b32 s38, 295424
    buffer_load_dwordx4 v[64:67], v204, s[88:91], s38 offen sc1
    s_mov_b32 s38, 369280
    buffer_load_dwordx4 v[68:71], v204, s[88:91], s38 offen sc1
    s_mov_b32 s38, 443136
    buffer_load_dwordx4 v[72:75], v204, s[88:91], s38 offen sc1
    s_mov_b32 s38, 516992
    buffer_load_dwordx4 v[76:79], v204, s[88:91], s38 offen sc1
    s_mov_b32 s38, 590848
    buffer_load_dwordx4 v[80:83], v204, s[88:91], s38 offen sc1
    s_mov_b32 s38, 664704
    buffer_load_dwordx4 v[84:87], v204, s[88:91], s38 offen sc1
    s_mov_b32 s38, 738560
    buffer_load_dwordx4 v[88:91], v204, s[88:91], s38 offen sc1
    s_mov_b32 s38, 812416
    buffer_load_dwordx4 v[92:95], v204, s[88:91], s38 offen sc1
    s_mov_b32 s38, 886272
    buffer_load_dwordx4 v[96:99], v204, s[88:91], s38 offen sc1
    s_mov_b32 s38, 960128
    buffer_load_dwordx4 v[100:103], v204, s[88:91], s38 offen sc1
    s_mov_b32 s38, 1033984
    buffer_load_dwordx4 v[104:107], v204, s[88:91], s38 offen sc1
    s_mov_b32 s38, 1107840
    buffer_load_dwordx4 v[108:111], v204, s[88:91], s38 offen sc1
    buffer_store_dwordx2 v[254:255], v47, s[84:87], s96 offen offset:1024 sc0 sc1
    s_branch L_joinA
L_fastA:
    s_mov_b32 s38, 0
    buffer_load_dwordx4 v[48:51], v204, s[88:91], s38 offen sc1
    s_mov_b32 s38, 73856
    buffer_load_dwordx4 v[52:55], v204, s[88:91], s38 offen sc1
    s_mov_b32 s38, 147712
    buffer_load_dwordx4 v[56:59], v204, s[88:91], s38 offen sc1
    s_mov_b32 s38, 221568
    buffer_load_dwordx4 v[60:63], v204, s[88:91], s38 offen sc1
    s_mov_b32 s38, 295424
    buffer_load_dwordx4 v[64:67], v204, s[88:91], s38 offen sc1
    s_mov_b32 s38, 369280
    buffer_load_dwordx4 v[68:71], v204, s[88:91], s38 offen sc1
    s_mov_b32 s38, 443136
    buffer_load_dwordx4 v[72:75], v204, s[88:91], s38 offen sc1
    s_mov_b32 s38, 516992
    buffer_load_dwordx4 v[76:79], v204, s[88:91], s38 offen sc1
    s_mov_b32 s38, 590848
    buffer_load_dwordx4 v[80:83], v204, s[88:91], s38 offen sc1
    s_mov_b32 s38, 664704
    buffer_load_dwordx4 v[84:87], v204, s[88:91], s38 offen sc1
    s_mov_b32 s38, 738560
    buffer_load_dwordx4 v[88:91], v204, s[88:91], s38 offen sc1
    s_mov_b32 s38, 812416
    buffer_load_dwordx4 v[92:95], v204, s[88:91], s38 offen sc1
    s_mov_b32 s38, 886272
    buffer_load_dwordx4 v[96:99], v204, s[88:91], s38 offen sc1
    s_mov_b32 s38, 960128
    buffer_load_dwordx4 v[100:103], v204, s[88:91], s38 offen sc1
    s_mov_b32 s38, 1033984
    buffer_load_dwordx4 v[104:107], v204, s[88:91], s38 offen sc1
    s_mov_b32 s38, 1107840
    buffer_load_dwordx4 v[108:111], v204, s[88:91], s38 offen sc1
    s_waitcnt vmcnt(16)
    buffer_store_dwordx2 v[254:255], v47, s[84:87], s96 offen offset:1024 sc0 sc1
L_joinA:
    s_waitcnt vmcnt(16)
    v_lshlrev_b32 v160, 16, v48
    v_and_b32 v161, 0xffff0000, v48
    v_lshlrev_b32 v162, 16, v49
    v_and_b32 v163, 0xffff0000, v49
    v_lshlrev_b32 v164, 16, v50
    v_and_b32 v165, 0xffff0000, v50
    v_lshlrev_b32 v166, 16, v51
    v_and_b32 v167, 0xffff0000, v51
    s_waitcnt vmcnt(15)
    v_lshlrev_b32 v176, 16, v52
    v_and_b32 v177, 0xffff0000, v52
    v_lshlrev_b32 v178, 16, v53
    v_and_b32 v179, 0xffff0000, v53
    v_lshlrev_b32 v180, 16, v54
    v_and_b32 v181, 0xffff0000, v54
    v_lshlrev_b32 v182, 16, v55
    v_and_b32 v183, 0xffff0000, v55
    v_pk_add_f32 v[160:161], v[160:161], v[176:177]
    v_pk_add_f32 v[162:163], v[162:163], v[178:179]
    v_pk_add_f32 v[164:165], v[164:165], v[180:181]
    v_pk_add_f32 v[166:167], v[166:167], v[182:183]
    s_waitcnt vmcnt(14)
    v_lshlrev_b32 v176, 16, v56
    v_and_b32 v177, 0xffff0000, v56
    v_lshlrev_b32 v178, 16, v57
    v_and_b32 v179, 0xffff0000, v57
    v_lshlrev_b32 v180, 16, v58
    v_and_b32 v181, 0xffff0000, v58
    v_lshlrev_b32 v182, 16, v59
    v_and_b32 v183, 0xffff0000, v59
    v_pk_add_f32 v[160:161], v[160:161], v[176:177]
    v_pk_add_f32 v[162:163], v[162:163], v[178:179]
    v_pk_add_f32 v[164:165], v[164:165], v[180:181]
    v_pk_add_f32 v[166:167], v[166:167], v[182:183]
    s_waitcnt vmcnt(13)
    v_lshlrev_b32 v176, 16, v60
    v_and_b32 v177, 0xffff0000, v60
    v_lshlrev_b32 v178, 16, v61
    v_and_b32 v179, 0xffff0000, v61
    v_lshlrev_b32 v180, 16, v62
    v_and_b32 v181, 0xffff0000, v62
    v_lshlrev_b32 v182, 16, v63
    v_and_b32 v183, 0xffff0000, v63
    v_pk_add_f32 v[160:161], v[160:161], v[176:177]
    v_pk_add_f32 v[162:163], v[162:163], v[178:179]
    v_pk_add_f32 v[164:165], v[164:165], v[180:181]
    v_pk_add_f32 v[166:167], v[166:167], v[182:183]
    s_waitcnt vmcnt(12)
    v_lshlrev_b32 v176, 16, v64
    v_and_b32 v177, 0xffff0000, v64
    v_lshlrev_b32 v178, 16, v65
    v_and_b32 v179, 0xffff0000, v65
    v_lshlrev_b32 v180, 16, v66
    v_and_b32 v181, 0xffff0000, v66
    v_lshlrev_b32 v182, 16, v67
    v_and_b32 v183, 0xffff0000, v67
    v_pk_add_f32 v[160:161], v[160:161], v[176:177]
    v_pk_add_f32 v[162:163], v[162:163], v[178:179]
    v_pk_add_f32 v[164:165], v[164:165], v[180:181]
    v_pk_add_f32 v[166:167], v[166:167], v[182:183]
    s_waitcnt vmcnt(11)
    v_lshlrev_b32 v176, 16, v68
    v_and_b32 v177, 0xffff0000, v68
    v_lshlrev_b32 v178, 16, v69
    v_and_b32 v179, 0xffff0000, v69
    v_lshlrev_b32 v180, 16, v70
    v_and_b32 v181, 0xffff0000, v70
    v_lshlrev_b32 v182, 16, v71
    v_and_b32 v183, 0xffff0000, v71
    v_pk_add_f32 v[160:161], v[160:161], v[176:177]
    v_pk_add_f32 v[162:163], v[162:163], v[178:179]
    v_pk_add_f32 v[164:165], v[164:165], v[180:181]
    v_pk_add_f32 v[166:167], v[166:167], v[182:183]
    s_waitcnt vmcnt(10)
    v_lshlrev_b32 v176, 16, v72
    v_and_b32 v177, 0xffff0000, v72
    v_lshlrev_b32 v178, 16, v73
    v_and_b32 v179, 0xffff0000, v73
    v_lshlrev_b32 v180, 16, v74
    v_and_b32 v181, 0xffff0000, v74
    v_lshlrev_b32 v182, 16, v75
    v_and_b32 v183, 0xffff0000, v75
    v_pk_add_f32 v[160:161], v[160:161], v[176:177]
    v_pk_add_f32 v[162:163], v[162:163], v[178:179]
    v_pk_add_f32 v[164:165], v[164:165], v[180:181]
    v_pk_add_f32 v[166:167], v[166:167], v[182:183]
    s_waitcnt vmcnt(9)
    v_lshlrev_b32 v176, 16, v76
    v_and_b32 v177, 0xffff0000, v76
    v_lshlrev_b32 v178, 16, v77
    v_and_b32 v179, 0xffff0000, v77
    v_lshlrev_b32 v180, 16, v78
    v_and_b32 v181, 0xffff0000, v78
    v_lshlrev_b32 v182, 16, v79
    v_and_b32 v183, 0xffff0000, v79
    v_pk_add_f32 v[160:161], v[160:161], v[176:177]
    v_pk_add_f32 v[162:163], v[162:163], v[178:179]
    v_pk_add_f32 v[164:165], v[164:165], v[180:181]
    v_pk_add_f32 v[166:167], v[166:167], v[182:183]
    s_waitcnt vmcnt(8)
    v_lshlrev_b32 v176, 16, v80
    v_and_b32 v177, 0xffff0000, v80
    v_lshlrev_b32 v178, 16, v81
    v_and_b32 v179, 0xffff0000, v81
    v_lshlrev_b32 v180, 16, v82
    v_and_b32 v181, 0xffff0000, v82
    v_lshlrev_b32 v182, 16, v83
    v_and_b32 v183, 0xffff0000, v83
    v_pk_add_f32 v[160:161], v[160:161], v[176:177]
    v_pk_add_f32 v[162:163], v[162:163], v[178:179]
    v_pk_add_f32 v[164:165], v[164:165], v[180:181]
    v_pk_add_f32 v[166:167], v[166:167], v[182:183]
    s_waitcnt vmcnt(7)
    v_lshlrev_b32 v176, 16, v84
    v_and_b32 v177, 0xffff0000, v84
    v_lshlrev_b32 v178, 16, v85
    v_and_b32 v179, 0xffff0000, v85
    v_lshlrev_b32 v180, 16, v86
    v_and_b32 v181, 0xffff0000, v86
    v_lshlrev_b32 v182, 16, v87
    v_and_b32 v183, 0xffff0000, v87
    v_pk_add_f32 v[160:161], v[160:161], v[176:177]
    v_pk_add_f32 v[162:163], v[162:163], v[178:179]
    v_pk_add_f32 v[164:165], v[164:165], v[180:181]
    v_pk_add_f32 v[166:167], v[166:167], v[182:183]
    s_waitcnt vmcnt(6)
    v_lshlrev_b32 v176, 16, v88
    v_and_b32 v177, 0xffff0000, v88
    v_lshlrev_b32 v178, 16, v89
    v_and_b32 v179, 0xffff0000, v89
    v_lshlrev_b32 v180, 16, v90
    v_and_b32 v181, 0xffff0000, v90
    v_lshlrev_b32 v182, 16, v91
    v_and_b32 v183, 0xffff0000, v91
    v_pk_add_f32 v[160:161], v[160:161], v[176:177]
    v_pk_add_f32 v[162:163], v[162:163], v[178:179]
    v_pk_add_f32 v[164:165], v[164:165], v[180:181]
    v_pk_add_f32 v[166:167], v[166:167], v[182:183]
    s_waitcnt vmcnt(5)
    v_lshlrev_b32 v176, 16, v92
    v_and_b32 v177, 0xffff0000, v92
    v_lshlrev_b32 v178, 16, v93
    v_and_b32 v179, 0xffff0000, v93
    v_lshlrev_b32 v180, 16, v94
    v_and_b32 v181, 0xffff0000, v94
    v_lshlrev_b32 v182, 16, v95
    v_and_b32 v183, 0xffff0000, v95
    v_pk_add_f32 v[160:161], v[160:161], v[176:177]
    v_pk_add_f32 v[162:163], v[162:163], v[178:179]
    v_pk_add_f32 v[164:165], v[164:165], v[180:181]
    v_pk_add_f32 v[166:167], v[166:167], v[182:183]
    s_waitcnt vmcnt(4)
    v_lshlrev_b32 v176, 16, v96
    v_and_b32 v177, 0xffff0000, v96
    v_lshlrev_b32 v178, 16, v97
    v_and_b32 v179, 0xffff0000, v97
    v_lshlrev_b32 v180, 16, v98
    v_and_b32 v181, 0xffff0000, v98
    v_lshlrev_b32 v182, 16, v99
    v_and_b32 v183, 0xffff0000, v99
    v_pk_add_f32 v[160:161], v[160:161], v[176:177]
    v_pk_add_f32 v[162:163], v[162:163], v[178:179]
    v_pk_add_f32 v[164:165], v[164:165], v[180:181]
    v_pk_add_f32 v[166:167], v[166:167], v[182:183]
    s_waitcnt vmcnt(3)
    v_lshlrev_b32 v176, 16, v100
    v_and_b32 v177, 0xffff0000, v100
    v_lshlrev_b32 v178, 16, v101
    v_and_b32 v179, 0xffff0000, v101
    v_lshlrev_b32 v180, 16, v102
    v_and_b32 v181, 0xffff0000, v102
    v_lshlrev_b32 v182, 16, v103
    v_and_b32 v183, 0xffff0000, v103
    v_pk_add_f32 v[160:161], v[160:161], v[176:177]
    v_pk_add_f32 v[162:163], v[162:163], v[178:179]
    v_pk_add_f32 v[164:165], v[164:165], v[180:181]
    v_pk_add_f32 v[166:167], v[166:167], v[182:183]
    s_waitcnt vmcnt(2)
    v_lshlrev_b32 v176, 16, v104
    v_and_b32 v177, 0xffff0000, v104
    v_lshlrev_b32 v178, 16, v105
    v_and_b32 v179, 0xffff0000, v105
    v_lshlrev_b32 v180, 16, v106
    v_and_b32 v181, 0xffff0000, v106
    v_lshlrev_b32 v182, 16, v107
    v_and_b32 v183, 0xffff0000, v107
    v_pk_add_f32 v[160:161], v[160:161], v[176:177]
    v_pk_add_f32 v[162:163], v[162:163], v[178:179]
    v_pk_add_f32 v[164:165], v[164:165], v[180:181]
    v_pk_add_f32 v[166:167], v[166:167], v[182:183]
    s_waitcnt vmcnt(1)
    v_lshlrev_b32 v176, 16, v108
    v_and_b32 v177, 0xffff0000, v108
    v_lshlrev_b32 v178, 16, v109
    v_and_b32 v179, 0xffff0000, v109
    v_lshlrev_b32 v180, 16, v110
    v_and_b32 v181, 0xffff0000, v110
    v_lshlrev_b32 v182, 16, v111
    v_and_b32 v183, 0xffff0000, v111
    v_pk_add_f32 v[160:161], v[160:161], v[176:177]
    v_pk_add_f32 v[162:163], v[162:163], v[178:179]
    v_pk_add_f32 v[164:165], v[164:165], v[180:181]
    v_pk_add_f32 v[166:167], v[166:167], v[182:183]
    v_cvt_pk_bf16_f32 v168, v160, v161
    v_cvt_pk_bf16_f32 v169, v162, v163
    v_cvt_pk_bf16_f32 v170, v164, v165
    v_cvt_pk_bf16_f32 v171, v166, v167
    buffer_store_dwordx2 v[168:169], v207, s[92:95], 0 offen
    buffer_store_dwordx2 v[170:171], v208, s[92:95], 0 offen
    s_mov_b32 s39, 0
L_pollBA:
    buffer_load_dwordx2 v[216:217], v206, s[84:87], 0 offen offset:1024 sc0 sc1
    s_waitcnt vmcnt(0)
    v_cmp_eq_u64 vcc, s[98:99], v[216:217]
    s_nop 1
    s_cmp_eq_u64 vcc, exec
    s_cbranch_scc1 L_goBA
    s_sleep 1
    s_add_u32 s39, s39, 1
    s_cmp_lt_u32 s39, 0x20000
    s_cbranch_scc1 L_pollBA
L_goBA:
    s_mov_b32 s38, 0
    buffer_load_dwordx4 v[112:115], v205, s[88:91], s38 offen sc1
    s_mov_b32 s38, 73856
    buffer_load_dwordx4 v[116:119], v205, s[88:91], s38 offen sc1
    s_mov_b32 s38, 147712
    buffer_load_dwordx4 v[120:123], v205, s[88:91], s38 offen sc1
    s_mov_b32 s38, 221568
    buffer_load_dwordx4 v[124:127], v205, s[88:91], s38 offen sc1
    s_mov_b32 s38, 295424
    buffer_load_dwordx4 v[128:131], v205, s[88:91], s38 offen sc1
    s_mov_b32 s38, 369280
    buffer_load_dwordx4 v[132:135], v205, s[88:91], s38 offen sc1
    s_mov_b32 s38, 443136
    buffer_load_dwordx4 v[136:139], v205, s[88:91], s38 offen sc1
    s_mov_b32 s38, 516992
    buffer_load_dwordx4 v[140:143], v205, s[88:91], s38 offen sc1
    s_waitcnt vmcnt(7)
    v_lshlrev_b32 v144, 16, v112
    v_and_b32 v145, 0xffff0000, v112
    v_lshlrev_b32 v146, 16, v113
    v_and_b32 v147, 0xffff0000, v113
    v_lshlrev_b32 v148, 16, v114
    v_and_b32 v149, 0xffff0000, v114
    v_lshlrev_b32 v150, 16, v115
    v_and_b32 v151, 0xffff0000, v115
    s_waitcnt vmcnt(6)
    v_lshlrev_b32 v176, 16, v116
    v_and_b32 v177, 0xffff0000, v116
    v_lshlrev_b32 v178, 16, v117
    v_and_b32 v179, 0xffff0000, v117
    v_lshlrev_b32 v180, 16, v118
    v_and_b32 v181, 0xffff0000, v118
    v_lshlrev_b32 v182, 16, v119
    v_and_b32 v183, 0xffff0000, v119
    v_pk_add_f32 v[144:145], v[144:145], v[176:177]
    v_pk_add_f32 v[146:147], v[146:147], v[178:179]
    v_pk_add_f32 v[148:149], v[148:149], v[180:181]
    v_pk_add_f32 v[150:151], v[150:151], v[182:183]
    s_waitcnt vmcnt(5)
    v_lshlrev_b32 v176, 16, v120
    v_and_b32 v177, 0xffff0000, v120
    v_lshlrev_b32 v178, 16, v121
    v_and_b32 v179, 0xffff0000, v121
    v_lshlrev_b32 v180, 16, v122
    v_and_b32 v181, 0xffff0000, v122
    v_lshlrev_b32 v182, 16, v123
    v_and_b32 v183, 0xffff0000, v123
    v_pk_add_f32 v[144:145], v[144:145], v[176:177]
    v_pk_add_f32 v[146:147], v[146:147], v[178:179]
    v_pk_add_f32 v[148:149], v[148:149], v[180:181]
    v_pk_add_f32 v[150:151], v[150:151], v[182:183]
    s_waitcnt vmcnt(4)
    v_lshlrev_b32 v176, 16, v124
    v_and_b32 v177, 0xffff0000, v124
    v_lshlrev_b32 v178, 16, v125
    v_and_b32 v179, 0xffff0000, v125
    v_lshlrev_b32 v180, 16, v126
    v_and_b32 v181, 0xffff0000, v126
    v_lshlrev_b32 v182, 16, v127
    v_and_b32 v183, 0xffff0000, v127
    v_pk_add_f32 v[144:145], v[144:145], v[176:177]
    v_pk_add_f32 v[146:147], v[146:147], v[178:179]
    v_pk_add_f32 v[148:149], v[148:149], v[180:181]
    v_pk_add_f32 v[150:151], v[150:151], v[182:183]
    s_waitcnt vmcnt(3)
    v_lshlrev_b32 v176, 16, v128
    v_and_b32 v177, 0xffff0000, v128
    v_lshlrev_b32 v178, 16, v129
    v_and_b32 v179, 0xffff0000, v129
    v_lshlrev_b32 v180, 16, v130
    v_and_b32 v181, 0xffff0000, v130
    v_lshlrev_b32 v182, 16, v131
    v_and_b32 v183, 0xffff0000, v131
    v_pk_add_f32 v[144:145], v[144:145], v[176:177]
    v_pk_add_f32 v[146:147], v[146:147], v[178:179]
    v_pk_add_f32 v[148:149], v[148:149], v[180:181]
    v_pk_add_f32 v[150:151], v[150:151], v[182:183]
    s_waitcnt vmcnt(2)
    v_lshlrev_b32 v176, 16, v132
    v_and_b32 v177, 0xffff0000, v132
    v_lshlrev_b32 v178, 16, v133
    v_and_b32 v179, 0xffff0000, v133
    v_lshlrev_b32 v180, 16, v134
    v_and_b32 v181, 0xffff0000, v134
    v_lshlrev_b32 v182, 16, v135
    v_and_b32 v183, 0xffff0000, v135
    v_pk_add_f32 v[144:145], v[144:145], v[176:177]
    v_pk_add_f32 v[146:147], v[146:147], v[178:179]
    v_pk_add_f32 v[148:149], v[148:149], v[180:181]
    v_pk_add_f32 v[150:151], v[150:151], v[182:183]
    s_waitcnt vmcnt(1)
    v_lshlrev_b32 v176, 16, v136
    v_and_b32 v177, 0xffff0000, v136
    v_lshlrev_b32 v178, 16, v137
    v_and_b32 v179, 0xffff0000, v137
    v_lshlrev_b32 v180, 16, v138
    v_and_b32 v181, 0xffff0000, v138
    v_lshlrev_b32 v182, 16, v139
    v_and_b32 v183, 0xffff0000, v139
    v_pk_add_f32 v[144:145], v[144:145], v[176:177]
    v_pk_add_f32 v[146:147], v[146:147], v[178:179]
    v_pk_add_f32 v[148:149], v[148:149], v[180:181]
    v_pk_add_f32 v[150:151], v[150:151], v[182:183]
    s_waitcnt vmcnt(0)
    v_lshlrev_b32 v176, 16, v140
    v_and_b32 v177, 0xffff0000, v140
    v_lshlrev_b32 v178, 16, v141
    v_and_b32 v179, 0xffff0000, v141
    v_lshlrev_b32 v180, 16, v142
    v_and_b32 v181, 0xffff0000, v142
    v_lshlrev_b32 v182, 16, v143
    v_and_b32 v183, 0xffff0000, v143
    v_pk_add_f32 v[144:145], v[144:145], v[176:177]
    v_pk_add_f32 v[146:147], v[146:147], v[178:179]
    v_pk_add_f32 v[148:149], v[148:149], v[180:181]
    v_pk_add_f32 v[150:151], v[150:151], v[182:183]
    v_mov_b32 v152, v144
    v_mov_b32 v153, v145
    v_mov_b32 v154, v146
    v_mov_b32 v155, v147
    v_mov_b32 v156, v148
    v_mov_b32 v157, v149
    v_mov_b32 v158, v150
    v_mov_b32 v159, v151
    v_permlane32_swap_b32 v144, v152
    v_permlane32_swap_b32 v145, v153
    v_permlane32_swap_b32 v146, v154
    v_permlane32_swap_b32 v147, v155
    v_permlane32_swap_b32 v148, v156
    v_permlane32_swap_b32 v149, v157
    v_permlane32_swap_b32 v150, v158
    v_permlane32_swap_b32 v151, v159
    v_add_f32 v144, v144, v152
    v_add_f32 v145, v145, v153
    v_add_f32 v146, v146, v154
    v_add_f32 v147, v147, v155
    v_add_f32 v148, v148, v156
    v_add_f32 v149, v149, v157
    v_add_f32 v150, v150, v158
    v_add_f32 v151, v151, v159
    v_cvt_pk_bf16_f32 v172, v144, v145
    v_cvt_pk_bf16_f32 v173, v146, v147
    v_cvt_pk_bf16_f32 v174, v148, v149
    v_cvt_pk_bf16_f32 v175, v150, v151
    buffer_store_dwordx2 v[172:173], v209, s[92:95], 0 offen
    buffer_store_dwordx2 v[174:175], v210, s[92:95], 0 offen
L_endA:
    s_endpgm
L_exit:
    s_endpgm
.section .rodata,"a"
.p2align 6
.amdhsa_kernel standalone__gqa_block_cached__near_ridge_kernel
  .amdhsa_next_free_vgpr 512
  .amdhsa_next_free_sgpr 102
  .amdhsa_accum_offset 256
  .amdhsa_group_segment_fixed_size 0
  .amdhsa_kernarg_size 64
  .amdhsa_user_sgpr_count 2
  .amdhsa_user_sgpr_kernarg_segment_ptr 1
  .amdhsa_system_sgpr_workgroup_id_x 1
  .amdhsa_float_denorm_mode_32 3
.end_amdhsa_kernel
```
